```python
import torch

def _softmax(x, axis=-1):
    return torch.softmax(x, dim=axis)
def _gelu(x):
    return torch.nn.functional.gelu(x, approximate="tanh")
def _silu(x):
    return torch.nn.functional.silu(x)
def _sigmoid(x):
    return torch.sigmoid(x)
def _layernorm(x, axis=-1, eps=1e-5):
    m = x.mean(dim=axis, keepdim=True)
    v = x.var(dim=axis, keepdim=True, unbiased=False)
    return (x - m) / torch.sqrt(v + eps)
def _scatter_add(tgt, idx, src, axis=0):
    return tgt.clone().index_add_(axis, idx, src)
def _segment_sum(src, seg, n):
    out = torch.zeros((n,) + src.shape[1:], dtype=src.dtype)
    return out.index_add_(0, seg, src)
def _pad(x, pw):
    flat = tuple(v for pair in reversed(pw) for v in pair)
    return torch.nn.functional.pad(x, flat)

kernel_name = 'parallel_sum__ssm_conv_s4d__glu_gated_geglu__prompt'

def setup_inputs():

    _w = (lambda a: (lambda t: t.to(torch.bfloat16) if t.is_floating_point() else t)(torch.as_tensor(a)))
    def _A_setup():
        Bsz, L, D, N = 1, 2048, 512, 128
        return {
            "u": _w((lambda *s: torch.randn(*s, dtype=torch.bfloat16) * 0.05)(Bsz, L, D)),
            "log_A_real": _w((lambda *s: torch.randn(*s, dtype=torch.bfloat16) * 6.4)(D, N) * 0.5),
            "A_imag": _w((lambda *s: torch.randn(*s, dtype=torch.bfloat16) * 0.05)(D, N) * 3.14),
            "C_real": _w((lambda *s: torch.randn(*s, dtype=torch.bfloat16) * 0.05)(D, N) / N ** 0.5),
            "C_imag": _w((lambda *s: torch.randn(*s, dtype=torch.bfloat16) * 0.05)(D, N) / N ** 0.5),
            "log_dt": _w((lambda *s: torch.randn(*s, dtype=torch.bfloat16) * 0.05)(D) * 0.5 - 4.0),
            "D_skip": _w((lambda *s: torch.randn(*s, dtype=torch.bfloat16) * 0.05)(D)),
        }
    _A_in = _A_setup()

    def _B_setup():
        B, S, Dm, Df = 1, 2048, 512, 1792
        return {
            "x": _w((lambda *s: torch.randn(*s, dtype=torch.bfloat16) * 0.05)(B, S, Dm)),
            "w_gate": _w((lambda *s: torch.randn(*s, dtype=torch.bfloat16) * 0.4)(Dm, Df) * (Dm ** -0.5)),
            "w_up": _w((lambda *s: torch.randn(*s, dtype=torch.bfloat16) * 0.4)(Dm, Df) * (Dm ** -0.5)),
            "w_down": _w((lambda *s: torch.randn(*s, dtype=torch.bfloat16) * 0.4)(Df, Dm) * (Df ** -0.5)),
        }
    _B_in = _B_setup()

    return {
        "A_u": _A_in["u"],
        "A_log_A_real": _A_in["log_A_real"],
        "A_A_imag": _A_in["A_imag"],
        "A_C_real": _A_in["C_real"],
        "A_C_imag": _A_in["C_imag"],
        "A_log_dt": _A_in["log_dt"],
        "A_D_skip": _A_in["D_skip"],
        "B_x": _B_in["x"],
        "B_w_gate": _B_in["w_gate"],
        "B_w_up": _B_in["w_up"],
        "B_w_down": _B_in["w_down"],
    }

def reference(A_u, A_log_A_real, A_A_imag, A_C_real, A_C_imag, A_log_dt, A_D_skip, B_x, B_w_gate, B_w_up, B_w_down):
    def _A_ref(u, log_A_real, A_imag, C_real, C_imag, log_dt, D_skip):
        L = u.shape[1]
        dt = torch.exp(log_dt)
        A = -torch.exp(log_A_real) + 1j * A_imag
        C = (C_real + 1j * C_imag) * dt[:, None]
        pos = (lambda x, dt: x.to(dt))(torch.arange(L), log_dt.dtype)
        P = torch.exp((A * dt[:, None])[:, :, None] * pos[None, None, :])
        K = 2.0 * torch.einsum("dn,dnl->dl", C, P).real
        L2 = 2 * L
        u_t = (lambda x, *d: x.permute(*d))(u, 0, 2, 1)
        Kf = (lambda x, *a, **k: torch.fft.rfft(x.float(), *a, **k))(K, L2)
        Uf = (lambda x, *a, **k: torch.fft.rfft(x.float(), *a, **k))(u_t, L2)
        y = (lambda x, *a, **k: torch.fft.irfft(x, *a, **k).to(torch.bfloat16))(Uf * Kf[None, :, :], L2)[:, :, :L]
        y = (lambda x, *d: x.permute(*d))(y, 0, 2, 1)
        return y + u * D_skip[None, None, :]

    def _B_ref(x, w_gate, w_up, w_down):
        g = torch.einsum("bsd,df->bsf", x, w_gate)
        u = torch.einsum("bsd,df->bsf", x, w_up)
        h = _gelu(g) * u
        return torch.einsum("bsf,fd->bsd", h, w_down)

    x = A_u
    xn = _layernorm(x, axis=-1)
    return x + _A_ref(xn, A_log_A_real, A_A_imag, A_C_real, A_C_imag, A_log_dt, A_D_skip) + _B_ref(xn, B_w_gate, B_w_up, B_w_down)
```

```asm
; @launch kernel=prep_kernel grid=(261,1,1) block=(256,1,1) lds=16384
; @launch kernel=main_kernel grid=(512,1,1) block=(256,1,1) lds=81920
.amdgcn_target "amdgcn-amd-amdhsa--gfx950"
.text
.globl prep_kernel
.p2align 8
.type prep_kernel,@function
prep_kernel:
    s_cmp_ge_u32 s2, 261
    s_cbranch_scc1 L0_exit
    s_load_dwordx2 s[4:5], s[0:1], 0
    s_load_dwordx2 s[18:19], s[0:1], 80
    s_load_dwordx2 s[16:17], s[0:1], 104

    s_waitcnt lgkmcnt(0)
    s_cmp_ge_u32 s2, 128
    s_cbranch_scc1 L0_swz

    s_and_b32 s3, s2, 7
    s_lshl_b32 s3, s3, 4
    s_lshr_b32 s2, s2, 3
    s_add_u32 s2, s2, s3

    s_mov_b32 s20, s4
    s_and_b32 s21, s5, 0xffff
    s_mov_b32 s22, 0x200000
    s_mov_b32 s23, 0x20000
    s_mov_b32 s24, s16
    s_and_b32 s25, s17, 0xffff
    s_mov_b32 s26, 0x204000
    s_mov_b32 s27, 0x20000
    s_add_u32 s28, s16, 0x400000
    s_addc_u32 s29, s17, 0
    s_and_b32 s29, s29, 0xffff
    s_mov_b32 s30, 0x200000
    s_mov_b32 s31, 0x20000
    s_lshl_b32 s3, s2, 4
    v_lshrrev_b32 v1, 4, v0
    v_and_b32 v2, 15, v0
    v_add_u32 v3, s3, v1
    v_lshlrev_b32 v3, 10, v3
    v_lshl_add_u32 v3, v2, 4, v3

    buffer_load_dwordx4 v[8:11], v3, s[20:23], 0 offen offset:0
    buffer_load_dwordx4 v[12:15], v3, s[20:23], 0 offen offset:256
    buffer_load_dwordx4 v[16:19], v3, s[20:23], 0 offen offset:512
    buffer_load_dwordx4 v[20:23], v3, s[20:23], 0 offen offset:768
    s_add_u32 s40, s16, 0x1000000
    s_addc_u32 s41, s17, 0
    s_and_b32 s41, s41, 0xffff
    s_mov_b32 s42, 0x200000
    s_mov_b32 s43, 0x20000
    v_mov_b32 v32, -1
    v_mov_b32 v33, -1
    v_mov_b32 v34, -1
    v_mov_b32 v35, -1
    v_lshlrev_b32 v36, 4, v0
    s_lshl_b32 s32, s2, 14

    s_waitcnt vmcnt(0)
    v_lshlrev_b32 v32, 16, v8
    v_and_b32 v33, 0xffff0000, v8
    v_lshlrev_b32 v34, 16, v9
    v_and_b32 v35, 0xffff0000, v9
    v_lshlrev_b32 v36, 16, v10
    v_and_b32 v37, 0xffff0000, v10
    v_lshlrev_b32 v38, 16, v11
    v_and_b32 v39, 0xffff0000, v11
    v_lshlrev_b32 v40, 16, v12
    v_and_b32 v41, 0xffff0000, v12
    v_lshlrev_b32 v42, 16, v13
    v_and_b32 v43, 0xffff0000, v13
    v_lshlrev_b32 v44, 16, v14
    v_and_b32 v45, 0xffff0000, v14
    v_lshlrev_b32 v46, 16, v15
    v_and_b32 v47, 0xffff0000, v15
    v_lshlrev_b32 v48, 16, v16
    v_and_b32 v49, 0xffff0000, v16
    v_lshlrev_b32 v50, 16, v17
    v_and_b32 v51, 0xffff0000, v17
    v_lshlrev_b32 v52, 16, v18
    v_and_b32 v53, 0xffff0000, v18
    v_lshlrev_b32 v54, 16, v19
    v_and_b32 v55, 0xffff0000, v19
    v_lshlrev_b32 v56, 16, v20
    v_and_b32 v57, 0xffff0000, v20
    v_lshlrev_b32 v58, 16, v21
    v_and_b32 v59, 0xffff0000, v21
    v_lshlrev_b32 v60, 16, v22
    v_and_b32 v61, 0xffff0000, v22
    v_lshlrev_b32 v62, 16, v23
    v_and_b32 v63, 0xffff0000, v23
    v_add_f32 v4, v32, v33
    v_add_f32 v5, v34, v35
    v_add_f32 v4, v4, v36
    v_add_f32 v5, v5, v37
    v_add_f32 v4, v4, v38
    v_add_f32 v5, v5, v39
    v_add_f32 v4, v4, v40
    v_add_f32 v5, v5, v41
    v_add_f32 v4, v4, v42
    v_add_f32 v5, v5, v43
    v_add_f32 v4, v4, v44
    v_add_f32 v5, v5, v45
    v_add_f32 v4, v4, v46
    v_add_f32 v5, v5, v47
    v_add_f32 v4, v4, v48
    v_add_f32 v5, v5, v49
    v_add_f32 v4, v4, v50
    v_add_f32 v5, v5, v51
    v_add_f32 v4, v4, v52
    v_add_f32 v5, v5, v53
    v_add_f32 v4, v4, v54
    v_add_f32 v5, v5, v55
    v_add_f32 v4, v4, v56
    v_add_f32 v5, v5, v57
    v_add_f32 v4, v4, v58
    v_add_f32 v5, v5, v59
    v_add_f32 v4, v4, v60
    v_add_f32 v5, v5, v61
    v_add_f32 v4, v4, v62
    v_add_f32 v5, v5, v63
    v_add_f32 v4, v4, v5
    s_nop 1
    v_add_f32_dpp v4, v4, v4 row_ror:8 row_mask:0xf bank_mask:0xf
    s_nop 1
    v_add_f32_dpp v4, v4, v4 row_ror:4 row_mask:0xf bank_mask:0xf
    s_nop 1
    v_add_f32_dpp v4, v4, v4 row_ror:2 row_mask:0xf bank_mask:0xf
    s_nop 1
    v_add_f32_dpp v4, v4, v4 row_ror:1 row_mask:0xf bank_mask:0xf
    v_mul_f32 v4, 0x3b000000, v4
    v_sub_f32 v6, v32, v4
    v_mul_f32 v5, v6, v6
    v_sub_f32 v6, v33, v4
    v_mul_f32 v7, v6, v6
    v_sub_f32 v6, v34, v4
    v_fma_f32 v5, v6, v6, v5
    v_sub_f32 v64, v35, v4
    v_fma_f32 v7, v64, v64, v7
    v_sub_f32 v6, v36, v4
    v_fma_f32 v5, v6, v6, v5
    v_sub_f32 v64, v37, v4
    v_fma_f32 v7, v64, v64, v7
    v_sub_f32 v6, v38, v4
    v_fma_f32 v5, v6, v6, v5
    v_sub_f32 v64, v39, v4
    v_fma_f32 v7, v64, v64, v7
    v_sub_f32 v6, v40, v4
    v_fma_f32 v5, v6, v6, v5
    v_sub_f32 v64, v41, v4
    v_fma_f32 v7, v64, v64, v7
    v_sub_f32 v6, v42, v4
    v_fma_f32 v5, v6, v6, v5
    v_sub_f32 v64, v43, v4
    v_fma_f32 v7, v64, v64, v7
    v_sub_f32 v6, v44, v4
    v_fma_f32 v5, v6, v6, v5
    v_sub_f32 v64, v45, v4
    v_fma_f32 v7, v64, v64, v7
    v_sub_f32 v6, v46, v4
    v_fma_f32 v5, v6, v6, v5
    v_sub_f32 v64, v47, v4
    v_fma_f32 v7, v64, v64, v7
    v_sub_f32 v6, v48, v4
    v_fma_f32 v5, v6, v6, v5
    v_sub_f32 v64, v49, v4
    v_fma_f32 v7, v64, v64, v7
    v_sub_f32 v6, v50, v4
    v_fma_f32 v5, v6, v6, v5
    v_sub_f32 v64, v51, v4
    v_fma_f32 v7, v64, v64, v7
    v_sub_f32 v6, v52, v4
    v_fma_f32 v5, v6, v6, v5
    v_sub_f32 v64, v53, v4
    v_fma_f32 v7, v64, v64, v7
    v_sub_f32 v6, v54, v4
    v_fma_f32 v5, v6, v6, v5
    v_sub_f32 v64, v55, v4
    v_fma_f32 v7, v64, v64, v7
    v_sub_f32 v6, v56, v4
    v_fma_f32 v5, v6, v6, v5
    v_sub_f32 v64, v57, v4
    v_fma_f32 v7, v64, v64, v7
    v_sub_f32 v6, v58, v4
    v_fma_f32 v5, v6, v6, v5
    v_sub_f32 v64, v59, v4
    v_fma_f32 v7, v64, v64, v7
    v_sub_f32 v6, v60, v4
    v_fma_f32 v5, v6, v6, v5
    v_sub_f32 v64, v61, v4
    v_fma_f32 v7, v64, v64, v7
    v_sub_f32 v6, v62, v4
    v_fma_f32 v5, v6, v6, v5
    v_sub_f32 v64, v63, v4
    v_fma_f32 v7, v64, v64, v7
    v_add_f32 v5, v5, v7
    s_nop 1
    v_add_f32_dpp v5, v5, v5 row_ror:8 row_mask:0xf bank_mask:0xf
    s_nop 1
    v_add_f32_dpp v5, v5, v5 row_ror:4 row_mask:0xf bank_mask:0xf
    s_nop 1
    v_add_f32_dpp v5, v5, v5 row_ror:2 row_mask:0xf bank_mask:0xf
    s_nop 1
    v_add_f32_dpp v5, v5, v5 row_ror:1 row_mask:0xf bank_mask:0xf
    v_mul_f32 v5, 0x3b000000, v5
    v_cvt_pk_bf16_f32 v4, v4, v5
    v_and_b32 v5, 0xffff0000, v4
    v_lshlrev_b32 v4, 16, v4
    v_add_f32 v5, 0x3727c5ac, v5
    v_cvt_pk_bf16_f32 v5, v5, v5
    v_lshlrev_b32 v5, 16, v5
    v_sqrt_f32 v5, v5
    s_nop 0
    v_cvt_pk_bf16_f32 v5, v5, v5
    v_lshlrev_b32 v5, 16, v5
    v_rcp_f32 v6, v5
    s_nop 0

    v_sub_f32 v32, v32, v4
    v_sub_f32 v33, v33, v4
    v_cvt_pk_bf16_f32 v7, v32, v33
    v_lshlrev_b32 v32, 16, v7
    v_and_b32 v33, 0xffff0000, v7
    v_mul_f32 v64, v32, v6
    v_mul_f32 v65, v33, v6
    v_fma_f32 v66, -v64, v5, v32
    v_fma_f32 v67, -v65, v5, v33
    v_fma_f32 v64, v66, v6, v64
    v_fma_f32 v65, v67, v6, v65
    v_cvt_pk_bf16_f32 v8, v64, v65

    v_sub_f32 v34, v34, v4
    v_sub_f32 v35, v35, v4
    v_cvt_pk_bf16_f32 v7, v34, v35
    v_lshlrev_b32 v34, 16, v7
    v_and_b32 v35, 0xffff0000, v7
    v_mul_f32 v64, v34, v6
    v_mul_f32 v65, v35, v6
    v_fma_f32 v66, -v64, v5, v34
    v_fma_f32 v67, -v65, v5, v35
    v_fma_f32 v64, v66, v6, v64
    v_fma_f32 v65, v67, v6, v65
    v_cvt_pk_bf16_f32 v9, v64, v65

    v_sub_f32 v36, v36, v4
    v_sub_f32 v37, v37, v4
    v_cvt_pk_bf16_f32 v7, v36, v37
    v_lshlrev_b32 v36, 16, v7
    v_and_b32 v37, 0xffff0000, v7
    v_mul_f32 v64, v36, v6
    v_mul_f32 v65, v37, v6
    v_fma_f32 v66, -v64, v5, v36
    v_fma_f32 v67, -v65, v5, v37
    v_fma_f32 v64, v66, v6, v64
    v_fma_f32 v65, v67, v6, v65
    v_cvt_pk_bf16_f32 v10, v64, v65

    v_sub_f32 v38, v38, v4
    v_sub_f32 v39, v39, v4
    v_cvt_pk_bf16_f32 v7, v38, v39
    v_lshlrev_b32 v38, 16, v7
    v_and_b32 v39, 0xffff0000, v7
    v_mul_f32 v64, v38, v6
    v_mul_f32 v65, v39, v6
    v_fma_f32 v66, -v64, v5, v38
    v_fma_f32 v67, -v65, v5, v39
    v_fma_f32 v64, v66, v6, v64
    v_fma_f32 v65, v67, v6, v65
    v_cvt_pk_bf16_f32 v11, v64, v65

    v_sub_f32 v40, v40, v4
    v_sub_f32 v41, v41, v4
    v_cvt_pk_bf16_f32 v7, v40, v41
    v_lshlrev_b32 v40, 16, v7
    v_and_b32 v41, 0xffff0000, v7
    v_mul_f32 v64, v40, v6
    v_mul_f32 v65, v41, v6
    v_fma_f32 v66, -v64, v5, v40
    v_fma_f32 v67, -v65, v5, v41
    v_fma_f32 v64, v66, v6, v64
    v_fma_f32 v65, v67, v6, v65
    v_cvt_pk_bf16_f32 v12, v64, v65

    v_sub_f32 v42, v42, v4
    v_sub_f32 v43, v43, v4
    v_cvt_pk_bf16_f32 v7, v42, v43
    v_lshlrev_b32 v42, 16, v7
    v_and_b32 v43, 0xffff0000, v7
    v_mul_f32 v64, v42, v6
    v_mul_f32 v65, v43, v6
    v_fma_f32 v66, -v64, v5, v42
    v_fma_f32 v67, -v65, v5, v43
    v_fma_f32 v64, v66, v6, v64
    v_fma_f32 v65, v67, v6, v65
    v_cvt_pk_bf16_f32 v13, v64, v65

    v_sub_f32 v44, v44, v4
    v_sub_f32 v45, v45, v4
    v_cvt_pk_bf16_f32 v7, v44, v45
    v_lshlrev_b32 v44, 16, v7
    v_and_b32 v45, 0xffff0000, v7
    v_mul_f32 v64, v44, v6
    v_mul_f32 v65, v45, v6
    v_fma_f32 v66, -v64, v5, v44
    v_fma_f32 v67, -v65, v5, v45
    v_fma_f32 v64, v66, v6, v64
    v_fma_f32 v65, v67, v6, v65
    v_cvt_pk_bf16_f32 v14, v64, v65

    v_sub_f32 v46, v46, v4
    v_sub_f32 v47, v47, v4
    v_cvt_pk_bf16_f32 v7, v46, v47
    v_lshlrev_b32 v46, 16, v7
    v_and_b32 v47, 0xffff0000, v7
    v_mul_f32 v64, v46, v6
    v_mul_f32 v65, v47, v6
    v_fma_f32 v66, -v64, v5, v46
    v_fma_f32 v67, -v65, v5, v47
    v_fma_f32 v64, v66, v6, v64
    v_fma_f32 v65, v67, v6, v65
    v_cvt_pk_bf16_f32 v15, v64, v65

    v_sub_f32 v48, v48, v4
    v_sub_f32 v49, v49, v4
    v_cvt_pk_bf16_f32 v7, v48, v49
    v_lshlrev_b32 v48, 16, v7
    v_and_b32 v49, 0xffff0000, v7
    v_mul_f32 v64, v48, v6
    v_mul_f32 v65, v49, v6
    v_fma_f32 v66, -v64, v5, v48
    v_fma_f32 v67, -v65, v5, v49
    v_fma_f32 v64, v66, v6, v64
    v_fma_f32 v65, v67, v6, v65
    v_cvt_pk_bf16_f32 v16, v64, v65

    v_sub_f32 v50, v50, v4
    v_sub_f32 v51, v51, v4
    v_cvt_pk_bf16_f32 v7, v50, v51
    v_lshlrev_b32 v50, 16, v7
    v_and_b32 v51, 0xffff0000, v7
    v_mul_f32 v64, v50, v6
    v_mul_f32 v65, v51, v6
    v_fma_f32 v66, -v64, v5, v50
    v_fma_f32 v67, -v65, v5, v51
    v_fma_f32 v64, v66, v6, v64
    v_fma_f32 v65, v67, v6, v65
    v_cvt_pk_bf16_f32 v17, v64, v65

    v_sub_f32 v52, v52, v4
    v_sub_f32 v53, v53, v4
    v_cvt_pk_bf16_f32 v7, v52, v53
    v_lshlrev_b32 v52, 16, v7
    v_and_b32 v53, 0xffff0000, v7
    v_mul_f32 v64, v52, v6
    v_mul_f32 v65, v53, v6
    v_fma_f32 v66, -v64, v5, v52
    v_fma_f32 v67, -v65, v5, v53
    v_fma_f32 v64, v66, v6, v64
    v_fma_f32 v65, v67, v6, v65
    v_cvt_pk_bf16_f32 v18, v64, v65

    v_sub_f32 v54, v54, v4
    v_sub_f32 v55, v55, v4
    v_cvt_pk_bf16_f32 v7, v54, v55
    v_lshlrev_b32 v54, 16, v7
    v_and_b32 v55, 0xffff0000, v7
    v_mul_f32 v64, v54, v6
    v_mul_f32 v65, v55, v6
    v_fma_f32 v66, -v64, v5, v54
    v_fma_f32 v67, -v65, v5, v55
    v_fma_f32 v64, v66, v6, v64
    v_fma_f32 v65, v67, v6, v65
    v_cvt_pk_bf16_f32 v19, v64, v65

    v_sub_f32 v56, v56, v4
    v_sub_f32 v57, v57, v4
    v_cvt_pk_bf16_f32 v7, v56, v57
    v_lshlrev_b32 v56, 16, v7
    v_and_b32 v57, 0xffff0000, v7
    v_mul_f32 v64, v56, v6
    v_mul_f32 v65, v57, v6
    v_fma_f32 v66, -v64, v5, v56
    v_fma_f32 v67, -v65, v5, v57
    v_fma_f32 v64, v66, v6, v64
    v_fma_f32 v65, v67, v6, v65
    v_cvt_pk_bf16_f32 v20, v64, v65

    v_sub_f32 v58, v58, v4
    v_sub_f32 v59, v59, v4
    v_cvt_pk_bf16_f32 v7, v58, v59
    v_lshlrev_b32 v58, 16, v7
    v_and_b32 v59, 0xffff0000, v7
    v_mul_f32 v64, v58, v6
    v_mul_f32 v65, v59, v6
    v_fma_f32 v66, -v64, v5, v58
    v_fma_f32 v67, -v65, v5, v59
    v_fma_f32 v64, v66, v6, v64
    v_fma_f32 v65, v67, v6, v65
    v_cvt_pk_bf16_f32 v21, v64, v65

    v_sub_f32 v60, v60, v4
    v_sub_f32 v61, v61, v4
    v_cvt_pk_bf16_f32 v7, v60, v61
    v_lshlrev_b32 v60, 16, v7
    v_and_b32 v61, 0xffff0000, v7
    v_mul_f32 v64, v60, v6
    v_mul_f32 v65, v61, v6
    v_fma_f32 v66, -v64, v5, v60
    v_fma_f32 v67, -v65, v5, v61
    v_fma_f32 v64, v66, v6, v64
    v_fma_f32 v65, v67, v6, v65
    v_cvt_pk_bf16_f32 v22, v64, v65

    v_sub_f32 v62, v62, v4
    v_sub_f32 v63, v63, v4
    v_cvt_pk_bf16_f32 v7, v62, v63
    v_lshlrev_b32 v62, 16, v7
    v_and_b32 v63, 0xffff0000, v7
    v_mul_f32 v64, v62, v6
    v_mul_f32 v65, v63, v6
    v_fma_f32 v66, -v64, v5, v62
    v_fma_f32 v67, -v65, v5, v63
    v_fma_f32 v64, v66, v6, v64
    v_fma_f32 v65, v67, v6, v65
    v_cvt_pk_bf16_f32 v23, v64, v65

    v_lshlrev_b32 v7, 10, v1
    v_lshl_add_u32 v7, v2, 4, v7
    v_lshrrev_b32 v64, 1, v2
    v_lshlrev_b32 v64, 10, v64
    v_and_b32 v65, 1, v2
    v_lshl_add_u32 v64, v65, 9, v64
    v_lshl_add_u32 v64, v1, 4, v64
    s_lshr_b32 s34, s2, 1
    s_mul_i32 s34, s34, 33024
    s_and_b32 s35, s2, 1
    s_lshl_b32 s35, s35, 8
    s_add_u32 s34, s34, s35
    s_add_u32 s35, s34, 0x2000
    s_add_u32 s36, s34, 0x4000
    s_add_u32 s37, s34, 0x6000

    buffer_store_dwordx4 v[8:11], v64, s[24:27], s34 offen
    ds_write_b128 v7, v[8:11] offset:0
    buffer_store_dwordx4 v[12:15], v64, s[24:27], s35 offen
    ds_write_b128 v7, v[12:15] offset:256
    buffer_store_dwordx4 v[16:19], v64, s[24:27], s36 offen
    ds_write_b128 v7, v[16:19] offset:512
    buffer_store_dwordx4 v[20:23], v64, s[24:27], s37 offen
    ds_write_b128 v7, v[20:23] offset:768
    s_waitcnt lgkmcnt(0)
    s_barrier
    v_lshlrev_b32 v7, 2, v0

    ds_read_b32 v32, v7 offset:0
    ds_read_b32 v33, v7 offset:1024
    ds_read_b32 v34, v7 offset:2048
    ds_read_b32 v35, v7 offset:3072
    ds_read_b32 v36, v7 offset:4096
    ds_read_b32 v37, v7 offset:5120
    ds_read_b32 v38, v7 offset:6144
    ds_read_b32 v39, v7 offset:7168
    ds_read_b32 v40, v7 offset:8192
    ds_read_b32 v41, v7 offset:9216
    ds_read_b32 v42, v7 offset:10240
    ds_read_b32 v43, v7 offset:11264
    ds_read_b32 v44, v7 offset:12288
    ds_read_b32 v45, v7 offset:13312
    ds_read_b32 v46, v7 offset:14336
    ds_read_b32 v47, v7 offset:15360
    s_mov_b32 s32, 0x05040100
    s_mov_b32 s33, 0x07060302
    v_lshlrev_b32 v3, 13, v0
    s_lshl_b32 s3, s3, 1
    v_add_u32 v3, s3, v3
    s_waitcnt lgkmcnt(0)

    v_perm_b32 v48, v33, v32, s32
    v_perm_b32 v56, v33, v32, s33
    v_perm_b32 v49, v35, v34, s32
    v_perm_b32 v57, v35, v34, s33
    v_perm_b32 v50, v37, v36, s32
    v_perm_b32 v58, v37, v36, s33
    v_perm_b32 v51, v39, v38, s32
    v_perm_b32 v59, v39, v38, s33
    v_perm_b32 v52, v41, v40, s32
    v_perm_b32 v60, v41, v40, s33
    v_perm_b32 v53, v43, v42, s32
    v_perm_b32 v61, v43, v42, s33
    v_perm_b32 v54, v45, v44, s32
    v_perm_b32 v62, v45, v44, s33
    v_perm_b32 v55, v47, v46, s32
    v_perm_b32 v63, v47, v46, s33
    buffer_store_dwordx4 v[48:51], v3, s[28:31], 0 offen
    buffer_store_dwordx4 v[52:55], v3, s[28:31], 0 offen offset:16
    v_add_u32 v3, 0x1000, v3
    buffer_store_dwordx4 v[56:59], v3, s[28:31], 0 offen
    buffer_store_dwordx4 v[60:63], v3, s[28:31], 0 offen offset:16
    s_branch L0_fin

L0_swz:
    s_add_u32 s2, s2, 112
    s_cmp_ge_u32 s2, 240
    s_cbranch_scc1 L0_zero

    s_add_u32 s24, s16, 0x1200000
    s_addc_u32 s25, s17, 0
    s_and_b32 s25, s25, 0xffff
    s_mov_b32 s26, 0x1d3000
    s_mov_b32 s27, 0x20000
    s_mov_b32 s20, s18
    s_and_b32 s21, s19, 0xffff
    s_mov_b32 s22, 0x1c0000
    s_mov_b32 s23, 0x20000
    s_sub_u32 s3, s2, 128
    s_lshl_b32 s32, s3, 14
    v_lshlrev_b32 v1, 2, v0
    s_add_u32 s33, s32, 0x1000
    s_add_u32 s34, s32, 0x2000
    s_add_u32 s35, s32, 0x3000

    buffer_load_dword v8, v1, s[20:23], s32 offen offset:0
    buffer_load_dword v9, v1, s[20:23], s32 offen offset:1024
    buffer_load_dword v10, v1, s[20:23], s32 offen offset:2048
    buffer_load_dword v11, v1, s[20:23], s32 offen offset:3072
    buffer_load_dword v12, v1, s[20:23], s33 offen offset:0
    buffer_load_dword v13, v1, s[20:23], s33 offen offset:1024
    buffer_load_dword v14, v1, s[20:23], s33 offen offset:2048
    buffer_load_dword v15, v1, s[20:23], s33 offen offset:3072
    buffer_load_dword v16, v1, s[20:23], s34 offen offset:0
    buffer_load_dword v17, v1, s[20:23], s34 offen offset:1024
    buffer_load_dword v18, v1, s[20:23], s34 offen offset:2048
    buffer_load_dword v19, v1, s[20:23], s34 offen offset:3072
    buffer_load_dword v20, v1, s[20:23], s35 offen offset:0
    buffer_load_dword v21, v1, s[20:23], s35 offen offset:1024
    buffer_load_dword v22, v1, s[20:23], s35 offen offset:2048
    buffer_load_dword v23, v1, s[20:23], s35 offen offset:3072
    v_lshrrev_b32 v2, 4, v0
    v_mul_u32_u24 v2, 119552, v2
    v_and_b32 v3, 15, v0
    v_lshl_add_u32 v2, v3, 5, v2
    s_mul_i32 s36, s3, 147
    s_lshr_b32 s36, s36, 12
    s_add_u32 s36, s36, s3
    s_lshl_b32 s36, s36, 10
    s_mov_b32 s37, 0x05040100
    s_mov_b32 s38, 0x07060302

    s_waitcnt vmcnt(4)
    v_perm_b32 v32, v9, v8, s37
    v_perm_b32 v36, v9, v8, s38
    v_perm_b32 v33, v11, v10, s37
    v_perm_b32 v37, v11, v10, s38
    v_perm_b32 v34, v17, v16, s37
    v_perm_b32 v38, v17, v16, s38
    v_perm_b32 v35, v19, v18, s37
    v_perm_b32 v39, v19, v18, s38
    s_waitcnt vmcnt(0)
    v_perm_b32 v40, v13, v12, s37
    v_perm_b32 v44, v13, v12, s38
    v_perm_b32 v41, v15, v14, s37
    v_perm_b32 v45, v15, v14, s38
    v_perm_b32 v42, v21, v20, s37
    v_perm_b32 v46, v21, v20, s38
    v_perm_b32 v43, v23, v22, s37
    v_perm_b32 v47, v23, v22, s38
    buffer_store_dwordx4 v[32:35], v2, s[24:27], s36 offen offset:0
    buffer_store_dwordx4 v[36:39], v2, s[24:27], s36 offen offset:16
    buffer_store_dwordx4 v[40:43], v2, s[24:27], s36 offen offset:512
    buffer_store_dwordx4 v[44:47], v2, s[24:27], s36 offen offset:528
    s_branch L0_fin
L0_zero:
    s_cmp_ge_u32 s2, 241
    s_cbranch_scc1 L0_tab

    s_add_u32 s24, s16, 0x1400000
    s_addc_u32 s25, s17, 0
    s_and_b32 s25, s25, 0xffff
    s_mov_b32 s26, 0x18000
    s_mov_b32 s27, 0x20000
    v_lshlrev_b32 v1, 4, v0
    v_mov_b32 v4, 0
    v_mov_b32 v5, 0
    v_mov_b32 v6, 0
    v_mov_b32 v7, 0

    s_mov_b32 s32, 0
    buffer_store_dwordx4 v[4:7], v1, s[24:27], s32 offen
    s_mov_b32 s32, 4096
    buffer_store_dwordx4 v[4:7], v1, s[24:27], s32 offen
    s_mov_b32 s32, 8192
    buffer_store_dwordx4 v[4:7], v1, s[24:27], s32 offen
    s_mov_b32 s32, 12288
    buffer_store_dwordx4 v[4:7], v1, s[24:27], s32 offen
    s_mov_b32 s32, 16384
    buffer_store_dwordx4 v[4:7], v1, s[24:27], s32 offen
    s_mov_b32 s32, 20480
    buffer_store_dwordx4 v[4:7], v1, s[24:27], s32 offen
    s_mov_b32 s32, 24576
    buffer_store_dwordx4 v[4:7], v1, s[24:27], s32 offen
    s_mov_b32 s32, 28672
    buffer_store_dwordx4 v[4:7], v1, s[24:27], s32 offen
    s_mov_b32 s32, 32768
    buffer_store_dwordx4 v[4:7], v1, s[24:27], s32 offen
    s_mov_b32 s32, 36864
    buffer_store_dwordx4 v[4:7], v1, s[24:27], s32 offen
    s_mov_b32 s32, 40960
    buffer_store_dwordx4 v[4:7], v1, s[24:27], s32 offen
    s_mov_b32 s32, 45056
    buffer_store_dwordx4 v[4:7], v1, s[24:27], s32 offen
    s_mov_b32 s32, 49152
    buffer_store_dwordx4 v[4:7], v1, s[24:27], s32 offen
    s_mov_b32 s32, 53248
    buffer_store_dwordx4 v[4:7], v1, s[24:27], s32 offen
    s_mov_b32 s32, 57344
    buffer_store_dwordx4 v[4:7], v1, s[24:27], s32 offen
    s_mov_b32 s32, 61440
    buffer_store_dwordx4 v[4:7], v1, s[24:27], s32 offen
    s_mov_b32 s32, 65536
    buffer_store_dwordx4 v[4:7], v1, s[24:27], s32 offen
    s_mov_b32 s32, 69632
    buffer_store_dwordx4 v[4:7], v1, s[24:27], s32 offen
    s_mov_b32 s32, 73728
    buffer_store_dwordx4 v[4:7], v1, s[24:27], s32 offen
    s_mov_b32 s32, 77824
    buffer_store_dwordx4 v[4:7], v1, s[24:27], s32 offen
    s_mov_b32 s32, 81920
    buffer_store_dwordx4 v[4:7], v1, s[24:27], s32 offen
    s_mov_b32 s32, 86016
    buffer_store_dwordx4 v[4:7], v1, s[24:27], s32 offen
    s_mov_b32 s32, 90112
    buffer_store_dwordx4 v[4:7], v1, s[24:27], s32 offen
    s_mov_b32 s32, 94208
    buffer_store_dwordx4 v[4:7], v1, s[24:27], s32 offen
    s_branch L0_fin
L0_tab:

    s_cmp_ge_u32 s2, 245
    s_cbranch_scc1 L0_pf

    s_add_u32 s24, s16, 0x1600000
    s_addc_u32 s25, s17, 0
    s_and_b32 s25, s25, 0xffff
    s_mov_b32 s26, 0x4000
    s_mov_b32 s27, 0x20000
    s_sub_u32 s3, s2, 241
    s_lshl_b32 s32, s3, 11
    v_lshl_add_u32 v1, v0, 3, s32
    v_lshrrev_b32 v2, 12, v1
    v_and_b32 v3, 4095, v1
    v_lshl_add_u32 v3, v2, 15, v3
    v_add_u32 v3, 0x3100, v3
    v_lshlrev_b32 v3, 16, v3
    v_lshlrev_b32 v1, 1, v1
    s_mov_b32 s47, 0xbdd2d3e8
    v_mov_b32 v10, 0xc0135761

    v_add_u32 v16, 0x0, v3
    v_add_u32 v17, 0x10000, v3
    v_add_u32 v18, 0x20000, v3
    v_add_u32 v19, 0x30000, v3
    v_add_u32 v20, 0x40000, v3
    v_add_u32 v21, 0x50000, v3
    v_add_u32 v22, 0x60000, v3
    v_add_u32 v23, 0x70000, v3
    v_mul_f32_e32 v24, v16, v16
    v_mul_f32_e32 v25, v17, v17
    v_mul_f32_e32 v26, v18, v18
    v_mul_f32_e32 v27, v19, v19
    v_mul_f32_e32 v28, v20, v20
    v_mul_f32_e32 v29, v21, v21
    v_mul_f32_e32 v30, v22, v22
    v_mul_f32_e32 v31, v23, v23
    v_fma_f32 v24, v24, s47, v10
    v_fma_f32 v25, v25, s47, v10
    v_fma_f32 v26, v26, s47, v10
    v_fma_f32 v27, v27, s47, v10
    v_fma_f32 v28, v28, s47, v10
    v_fma_f32 v29, v29, s47, v10
    v_fma_f32 v30, v30, s47, v10
    v_fma_f32 v31, v31, s47, v10
    v_mul_f32_e32 v24, v24, v16
    v_mul_f32_e32 v25, v25, v17
    v_mul_f32_e32 v26, v26, v18
    v_mul_f32_e32 v27, v27, v19
    v_mul_f32_e32 v28, v28, v20
    v_mul_f32_e32 v29, v29, v21
    v_mul_f32_e32 v30, v30, v22
    v_mul_f32_e32 v31, v31, v23
    v_exp_f32_e32 v24, v24
    v_exp_f32_e32 v25, v25
    v_exp_f32_e32 v26, v26
    v_exp_f32_e32 v27, v27
    v_exp_f32_e32 v28, v28
    v_exp_f32_e32 v29, v29
    v_exp_f32_e32 v30, v30
    v_exp_f32_e32 v31, v31
    s_nop 0
    v_add_f32_e32 v24, 1.0, v24
    v_add_f32_e32 v25, 1.0, v25
    v_add_f32_e32 v26, 1.0, v26
    v_add_f32_e32 v27, 1.0, v27
    v_add_f32_e32 v28, 1.0, v28
    v_add_f32_e32 v29, 1.0, v29
    v_add_f32_e32 v30, 1.0, v30
    v_add_f32_e32 v31, 1.0, v31
    v_rcp_f32_e32 v24, v24
    v_rcp_f32_e32 v25, v25
    v_rcp_f32_e32 v26, v26
    v_rcp_f32_e32 v27, v27
    v_rcp_f32_e32 v28, v28
    v_rcp_f32_e32 v29, v29
    v_rcp_f32_e32 v30, v30
    v_rcp_f32_e32 v31, v31
    s_nop 0
    v_mul_f32_e32 v24, v24, v16
    v_mul_f32_e32 v25, v25, v17
    v_mul_f32_e32 v26, v26, v18
    v_mul_f32_e32 v27, v27, v19
    v_mul_f32_e32 v28, v28, v20
    v_mul_f32_e32 v29, v29, v21
    v_mul_f32_e32 v30, v30, v22
    v_mul_f32_e32 v31, v31, v23
    v_cvt_pk_bf16_f32 v32, v24, v25
    v_cvt_pk_bf16_f32 v33, v26, v27
    v_cvt_pk_bf16_f32 v34, v28, v29
    v_cvt_pk_bf16_f32 v35, v30, v31
    buffer_store_dwordx4 v[32:35], v1, s[24:27], 0 offen
L0_fin:

L0_exit:
    s_endpgm

L0_pf:
    s_load_dwordx4 s[40:43], s[0:1], 64
    s_load_dwordx8 s[48:55], s[0:1], 8
    s_load_dwordx2 s[56:57], s[0:1], 88
    s_sub_u32 s3, s2, 245
    v_lshlrev_b32 v1, 4, v0
    s_waitcnt lgkmcnt(0)
    s_cmp_ge_u32 s3, 112
    s_cbranch_scc1 L0_pf2

    s_mov_b32 s20, s40
    s_and_b32 s21, s41, 0xffff
    s_mov_b32 s22, 0x1c0000
    s_mov_b32 s23, 0x20000
    s_mov_b32 s24, s42
    s_and_b32 s25, s43, 0xffff
    s_mov_b32 s26, 0x1c0000
    s_mov_b32 s27, 0x20000
    s_lshl_b32 s32, s3, 14
    s_add_u32 s33, s32, 0
    buffer_load_dwordx4 v[8:11], v1, s[20:23], s33 offen
    buffer_load_dwordx4 v[12:15], v1, s[24:27], s33 offen
    s_add_u32 s33, s32, 4096
    buffer_load_dwordx4 v[16:19], v1, s[20:23], s33 offen
    buffer_load_dwordx4 v[20:23], v1, s[24:27], s33 offen
    s_add_u32 s33, s32, 8192
    buffer_load_dwordx4 v[24:27], v1, s[20:23], s33 offen
    buffer_load_dwordx4 v[28:31], v1, s[24:27], s33 offen
    s_add_u32 s33, s32, 12288
    buffer_load_dwordx4 v[32:35], v1, s[20:23], s33 offen
    buffer_load_dwordx4 v[36:39], v1, s[24:27], s33 offen
    s_mov_b32 s28, s18
    s_and_b32 s29, s19, 0xffff
    s_mov_b32 s30, 0x1c0000
    s_mov_b32 s31, 0x20000
    s_add_u32 s34, s3, 5
    s_and_b32 s34, s34, 7
    s_lshr_b32 s35, s3, 4
    s_lshl_b32 s35, s35, 3
    s_add_u32 s34, s34, s35
    s_cmp_ge_u32 s34, 28
    s_cbranch_scc1 L0_pfd
    s_lshl_b32 s34, s34, 16
    s_bfe_u32 s35, s3, 0x10003
    s_lshl_b32 s35, s35, 15
    s_add_u32 s34, s34, s35

    s_add_u32 s33, s34, 0
    buffer_load_dwordx4 v[40:43], v1, s[28:31], s33 offen
    s_add_u32 s33, s34, 4096
    buffer_load_dwordx4 v[44:47], v1, s[28:31], s33 offen
    s_add_u32 s33, s34, 8192
    buffer_load_dwordx4 v[48:51], v1, s[28:31], s33 offen
    s_add_u32 s33, s34, 12288
    buffer_load_dwordx4 v[52:55], v1, s[28:31], s33 offen
    s_add_u32 s33, s34, 16384
    buffer_load_dwordx4 v[56:59], v1, s[28:31], s33 offen
    s_add_u32 s33, s34, 20480
    buffer_load_dwordx4 v[60:63], v1, s[28:31], s33 offen
    s_add_u32 s33, s34, 24576
    buffer_load_dwordx4 v[64:67], v1, s[28:31], s33 offen
    s_add_u32 s33, s34, 28672
    buffer_load_dwordx4 v[68:71], v1, s[28:31], s33 offen
L0_pfd:
    s_waitcnt vmcnt(0)
    s_branch L0_fin
L0_pf2:
    s_sub_u32 s3, s3, 112
    s_lshl_b32 s60, s3, 13

    s_mov_b32 s20, s48
    s_and_b32 s21, s49, 0xffff
    s_mov_b32 s22, 0x20000
    s_mov_b32 s23, 0x20000
    s_mov_b32 s24, s50
    s_and_b32 s25, s51, 0xffff
    s_mov_b32 s26, 0x20000
    s_mov_b32 s27, 0x20000
    s_mov_b32 s28, s52
    s_and_b32 s29, s53, 0xffff
    s_mov_b32 s30, 0x20000
    s_mov_b32 s31, 0x20000
    s_mov_b32 s32, s54
    s_and_b32 s33, s55, 0xffff
    s_mov_b32 s34, 0x20000
    s_mov_b32 s35, 0x20000
    s_add_u32 s61, s60, 0
    buffer_load_dwordx4 v[8:11], v1, s[20:23], s61 offen
    s_add_u32 s61, s60, 4096
    buffer_load_dwordx4 v[12:15], v1, s[20:23], s61 offen
    s_add_u32 s61, s60, 0
    buffer_load_dwordx4 v[16:19], v1, s[24:27], s61 offen
    s_add_u32 s61, s60, 4096
    buffer_load_dwordx4 v[20:23], v1, s[24:27], s61 offen
    s_add_u32 s61, s60, 0
    buffer_load_dwordx4 v[24:27], v1, s[28:31], s61 offen
    s_add_u32 s61, s60, 4096
    buffer_load_dwordx4 v[28:31], v1, s[28:31], s61 offen
    s_add_u32 s61, s60, 0
    buffer_load_dwordx4 v[32:35], v1, s[32:35], s61 offen
    s_add_u32 s61, s60, 4096
    buffer_load_dwordx4 v[36:39], v1, s[32:35], s61 offen
    s_waitcnt vmcnt(0)
    s_branch L0_fin

.globl main_kernel
.p2align 8
.type main_kernel,@function
main_kernel:
    s_cmp_ge_u32 s2, 512
    s_cbranch_scc1 L1_exit
    s_load_dwordx4 s[4:7], s[0:1], 64
    s_load_dwordx2 s[8:9], s[0:1], 48
    s_load_dwordx2 s[16:17], s[0:1], 104
    s_load_dwordx2 s[56:57], s[0:1], 0
    s_load_dwordx2 s[58:59], s[0:1], 88
    v_lshrrev_b32 v5, 6, v0
    v_mov_b32 v15, v0
    v_readfirstlane_b32 s3, v5
    v_and_b32 v0, 63, v0
    s_mov_b32 s96, s2

    s_waitcnt lgkmcnt(0)

    s_cmp_lt_u32 s2, 256
    s_cbranch_scc1 L1_conv

    s_sub_u32 s2, s2, 256

    s_add_u32 s28, s16, 0x800000
    s_addc_u32 s29, s17, 0
    s_and_b32 s29, s29, 0xffff
    s_mov_b32 s30, 0x74c000
    s_mov_b32 s31, 0x20000
    s_cmp_ge_u32 s2, 224
    s_cbranch_scc1 L1_h

    s_setprio 2
    s_mov_b32 s20, s16
    s_and_b32 s21, s17, 0xffff
    s_mov_b32 s22, 0x204000
    s_mov_b32 s23, 0x20000
    s_cmp_ge_u32 s3, 2
    s_cselect_b32 s24, s6, s4
    s_cselect_b32 s25, s7, s5
    s_and_b32 s25, s25, 0xffff
    s_mov_b32 s26, 0x1c0000
    s_mov_b32 s27, 0x20000

    s_lshr_b32 s12, s2, 3
    s_mul_i32 s13, s12, 37
    s_lshr_b32 s13, s13, 8
    s_mul_i32 s14, s13, 7
    s_sub_u32 s14, s12, s14
    s_and_b32 s15, s2, 3
    s_mov_b32 s97, s15
    s_mul_i32 s15, s15, 7
    s_add_u32 s10, s15, s14
    s_bfe_u32 s15, s2, 0x10002
    s_lshl_b32 s15, s15, 2
    s_add_u32 s11, s15, s13

    s_lshl_b32 s12, s11, 3
    s_lshl_b32 s13, s3, 1
    s_add_u32 s12, s12, s13
    s_mul_i32 s12, s12, 33024
    v_lshlrev_b32 v1, 4, v0
    v_add_u32 v1, s12, v1
    v_lshrrev_b32 v5, 3, v0
    v_and_b32 v6, 7, v0
    v_and_b32 v7, 3, v5
    v_lshlrev_b32 v7, 1, v7
    v_xor_b32 v6, v6, v7
    v_mul_u32_u24 v2, 3584, v5
    s_lshl_b32 s13, s10, 7
    v_add_u32 v2, s13, v2
    v_lshl_add_u32 v2, v6, 4, v2
    s_and_b32 s14, s3, 1
    s_mul_i32 s40, s14, 57344
    s_lshr_b32 s15, s3, 1
    s_lshl_b32 s42, s15, 12
    s_lshl_b32 s14, s14, 11
    s_add_u32 s42, s42, s14
    s_add_u32 s42, s42, 8192

    s_mov_b32 s32, 0
    s_mov_b32 s33, 4096
    s_mov_b32 s34, 8192
    s_mov_b32 s35, 12288
    s_mov_b32 s36, 16384
    s_mov_b32 s37, 20480
    s_mov_b32 s38, 24576
    s_mov_b32 s39, 28672
    s_mov_b32 s48, 33024
    s_mov_b32 s49, 37120
    s_mov_b32 s50, 41216
    s_mov_b32 s51, 45312
    s_mov_b32 s52, 49408
    s_mov_b32 s53, 53504
    s_mov_b32 s54, 57600
    s_mov_b32 s55, 61696
    s_add_u32 s41, s40, 0
    s_add_u32 m0, s42, 0
    s_nop 0
    buffer_load_dwordx4 v2, s[24:27], s41 offen lds
    s_add_u32 s41, s40, 28672
    s_add_u32 m0, s42, 1024
    s_nop 0
    buffer_load_dwordx4 v2, s[24:27], s41 offen lds
    buffer_load_dwordx4 v[168:171], v1, s[20:23], s32 offen offset:0
    buffer_load_dwordx4 v[172:175], v1, s[20:23], s48 offen offset:0
    buffer_load_dwordx4 v[176:179], v1, s[20:23], s32 offen offset:1024
    buffer_load_dwordx4 v[180:183], v1, s[20:23], s48 offen offset:1024
    s_add_u32 s41, s40, 114688
    s_add_u32 m0, s42, 8192
    s_nop 0
    buffer_load_dwordx4 v2, s[24:27], s41 offen lds
    s_add_u32 s41, s40, 143360
    s_add_u32 m0, s42, 9216
    s_nop 0
    buffer_load_dwordx4 v2, s[24:27], s41 offen lds
    buffer_load_dwordx4 v[184:187], v1, s[20:23], s32 offen offset:2048
    buffer_load_dwordx4 v[188:191], v1, s[20:23], s48 offen offset:2048
    buffer_load_dwordx4 v[192:195], v1, s[20:23], s32 offen offset:3072
    buffer_load_dwordx4 v[196:199], v1, s[20:23], s48 offen offset:3072
    s_add_u32 s41, s40, 229376
    s_add_u32 m0, s42, 16384
    s_nop 0
    buffer_load_dwordx4 v2, s[24:27], s41 offen lds
    s_add_u32 s41, s40, 258048
    s_add_u32 m0, s42, 17408
    s_nop 0
    buffer_load_dwordx4 v2, s[24:27], s41 offen lds
    buffer_load_dwordx4 v[200:203], v1, s[20:23], s33 offen offset:0
    buffer_load_dwordx4 v[204:207], v1, s[20:23], s49 offen offset:0
    buffer_load_dwordx4 v[208:211], v1, s[20:23], s33 offen offset:1024
    buffer_load_dwordx4 v[212:215], v1, s[20:23], s49 offen offset:1024
    v_bfe_u32 v7, v0, 2, 2
    v_lshrrev_b32 v6, 5, v0
    v_lshl_add_u32 v6, v6, 3, v7
    v_bfe_u32 v10, v0, 4, 1
    v_bfe_u32 v11, v0, 1, 1
    v_lshl_add_u32 v10, v10, 1, v11
    v_lshlrev_b32 v7, 1, v7
    v_xor_b32 v10, v10, v7
    v_lshlrev_b32 v8, 7, v6
    v_lshl_add_u32 v8, v10, 4, v8
    v_and_b32 v11, 1, v0
    v_lshl_add_u32 v8, v11, 3, v8
    v_xor_b32 v9, 64, v8

    s_add_u32 s84, s16, 0x1200000
    s_addc_u32 s85, s17, 0
    s_and_b32 s85, s85, 0xffff
    s_mov_b32 s86, 0x218000
    s_mov_b32 s87, 0x20000
    s_and_b32 s44, s2, 7
    s_lshl_b32 s44, s44, 2
    s_bfe_u32 s45, s2, 0x20003
    s_add_u32 s44, s44, s45
    s_lshr_b32 s45, s2, 5
    s_mul_i32 s14, s3, 29696
    s_mul_i32 s18, s44, 239104
    s_add_u32 s18, s18, s14
    s_mul_i32 s19, s45, 239104
    s_add_u32 s19, s19, s14
    s_lshl_b32 s43, s44, 2
    s_add_u32 s43, s43, s3
    s_lshl_b32 s43, s43, 8
    s_lshl_b32 s61, s3, 14
    s_add_u32 s8, s61, 8192
    s_cmp_eq_u32 s3, 0
    s_cselect_b32 s61, 73728, s61
    v_lshlrev_b32 v4, 4, v0
    v_add_u32 v5, 119552, v4
    s_lshr_b32 s4, s2, 3
    s_lshl_b32 s14, s3, 5
    s_add_u32 s4, s4, s14
    s_lshl_b32 s4, s4, 8
    s_add_u32 s4, s4, 2129920

    s_add_u32 s80, s16, 0x1600000
    s_addc_u32 s81, s17, 0
    s_and_b32 s81, s81, 0xffff
    s_mov_b32 s82, 0x4000
    s_mov_b32 s83, 0x20000
    s_lshl_b32 s62, s3, 12
    s_and_b32 s63, s3, 1
    s_lshl_b32 s63, s63, 12
    s_lshr_b32 s14, s3, 1
    s_lshl_b32 s14, s14, 16
    s_add_u32 s63, s63, s14
    s_lshl_b32 s12, s11, 3
    s_lshl_b32 s13, s3, 1
    s_add_u32 s12, s12, s13
    s_mul_i32 s12, s12, 119552
    s_lshl_b32 s13, s10, 2
    s_mul_i32 s14, s97, 1
    s_add_u32 s13, s13, s14
    s_lshl_b32 s13, s13, 10
    s_add_u32 s12, s12, s13
    s_add_u32 s13, s12, 119552
    s_mov_b32 s46, 0x31003100
    s_mov_b32 s47, 0xbdd2d3e8
    s_mov_b32 s98, 0x8fff8fff
    v_mov_b32 v10, 0xc0135761
    s_lshl_b32 s60, s11, 2
    s_add_u32 s60, s60, s3
    s_lshl_b32 s60, s60, 2
    s_add_u32 s60, s60, s97
    s_lshl_b32 s60, s60, 8

    s_waitcnt vmcnt(16)
    s_barrier
    ds_read_b64_tr_b16 v[144:145], v8 offset:8192
    ds_read_b64_tr_b16 v[146:147], v8 offset:8704
    ds_read_b64_tr_b16 v[148:149], v8 offset:12288
    ds_read_b64_tr_b16 v[150:151], v8 offset:12800
    ds_read_b64_tr_b16 v[152:153], v9 offset:8192
    ds_read_b64_tr_b16 v[154:155], v9 offset:8704
    ds_read_b64_tr_b16 v[156:157], v9 offset:12288
    ds_read_b64_tr_b16 v[158:159], v9 offset:12800
    ds_read_b64_tr_b16 v[160:161], v8 offset:10240
    ds_read_b64_tr_b16 v[162:163], v8 offset:10752
    s_waitcnt vmcnt(14)
    s_waitcnt lgkmcnt(8)
    v_mfma_f32_32x32x16_bf16 v[16:31], v[144:147], v[168:171], 0
    v_mfma_f32_32x32x16_bf16 v[48:63], v[144:147], v[172:175], 0
    s_add_u32 s41, s40, 344064
    s_add_u32 m0, s42, 24576
    s_nop 0
    buffer_load_dwordx4 v2, s[24:27], s41 offen lds
    ds_read_b64_tr_b16 v[164:165], v8 offset:14336
    ds_read_b64_tr_b16 v[166:167], v8 offset:14848
    s_waitcnt lgkmcnt(8)
    v_mfma_f32_32x32x16_bf16 v[32:47], v[148:151], v[168:171], 0
    v_mfma_f32_32x32x16_bf16 v[64:79], v[148:151], v[172:175], 0
    s_add_u32 s41, s40, 372736
    s_add_u32 m0, s42, 25600
    s_nop 0
    buffer_load_dwordx4 v2, s[24:27], s41 offen lds
    ds_read_b64_tr_b16 v[144:145], v9 offset:10240
    ds_read_b64_tr_b16 v[146:147], v9 offset:10752
    s_waitcnt lgkmcnt(8)
    v_mfma_f32_32x32x16_bf16 v[80:95], v[152:155], v[168:171], 0
    v_mfma_f32_32x32x16_bf16 v[112:127], v[152:155], v[172:175], 0
    buffer_load_dwordx4 v[216:219], v1, s[20:23], s33 offen offset:2048
    ds_read_b64_tr_b16 v[148:149], v9 offset:14336
    ds_read_b64_tr_b16 v[150:151], v9 offset:14848
    s_waitcnt lgkmcnt(8)
    v_mfma_f32_32x32x16_bf16 v[96:111], v[156:159], v[168:171], 0
    v_mfma_f32_32x32x16_bf16 v[128:143], v[156:159], v[172:175], 0
    buffer_load_dwordx4 v[220:223], v1, s[20:23], s49 offen offset:2048
    s_waitcnt vmcnt(14)
    s_barrier
    ds_read_b64_tr_b16 v[152:153], v8 offset:16384
    ds_read_b64_tr_b16 v[154:155], v8 offset:16896
    s_waitcnt vmcnt(16)
    s_waitcnt lgkmcnt(8)
    v_mfma_f32_32x32x16_bf16 v[16:31], v[160:163], v[176:179], v[16:31]
    v_mfma_f32_32x32x16_bf16 v[48:63], v[160:163], v[180:183], v[48:63]
    buffer_load_dwordx4 v[224:227], v1, s[20:23], s33 offen offset:3072
    ds_read_b64_tr_b16 v[156:157], v8 offset:20480
    ds_read_b64_tr_b16 v[158:159], v8 offset:20992
    s_waitcnt lgkmcnt(8)
    v_mfma_f32_32x32x16_bf16 v[32:47], v[164:167], v[176:179], v[32:47]
    v_mfma_f32_32x32x16_bf16 v[64:79], v[164:167], v[180:183], v[64:79]
    buffer_load_dwordx4 v[228:231], v1, s[20:23], s49 offen offset:3072
    ds_read_b64_tr_b16 v[160:161], v9 offset:16384
    ds_read_b64_tr_b16 v[162:163], v9 offset:16896
    s_waitcnt lgkmcnt(8)
    v_mfma_f32_32x32x16_bf16 v[80:95], v[144:147], v[176:179], v[80:95]
    v_mfma_f32_32x32x16_bf16 v[112:127], v[144:147], v[180:183], v[112:127]
    s_mov_b32 m0, s63
    s_nop 0
    buffer_load_dwordx4 v4, s[80:83], s62 offen offset:0 lds
    ds_read_b64_tr_b16 v[164:165], v9 offset:20480
    ds_read_b64_tr_b16 v[166:167], v9 offset:20992
    s_waitcnt lgkmcnt(8)
    v_mfma_f32_32x32x16_bf16 v[96:111], v[148:151], v[176:179], v[96:111]
    v_mfma_f32_32x32x16_bf16 v[128:143], v[148:151], v[180:183], v[128:143]
    s_mov_b32 m0, s63
    s_nop 0
    buffer_load_dwordx4 v4, s[80:83], s62 offen offset:1024 lds
    ds_read_b64_tr_b16 v[144:145], v8 offset:18432
    ds_read_b64_tr_b16 v[146:147], v8 offset:18944
    s_waitcnt vmcnt(16)
    s_waitcnt lgkmcnt(8)
    v_mfma_f32_32x32x16_bf16 v[16:31], v[152:155], v[184:187], v[16:31]
    v_mfma_f32_32x32x16_bf16 v[48:63], v[152:155], v[188:191], v[48:63]
    s_mov_b32 m0, s63
    s_nop 0
    buffer_load_dwordx4 v4, s[80:83], s62 offen offset:2048 lds
    ds_read_b64_tr_b16 v[148:149], v8 offset:22528
    ds_read_b64_tr_b16 v[150:151], v8 offset:23040
    s_waitcnt lgkmcnt(8)
    v_mfma_f32_32x32x16_bf16 v[32:47], v[156:159], v[184:187], v[32:47]
    v_mfma_f32_32x32x16_bf16 v[64:79], v[156:159], v[188:191], v[64:79]
    s_mov_b32 m0, s63
    s_nop 0
    buffer_load_dwordx4 v4, s[80:83], s62 offen offset:3072 lds
    ds_read_b64_tr_b16 v[152:153], v9 offset:18432
    ds_read_b64_tr_b16 v[154:155], v9 offset:18944
    s_waitcnt lgkmcnt(8)
    v_mfma_f32_32x32x16_bf16 v[80:95], v[160:163], v[184:187], v[80:95]
    v_mfma_f32_32x32x16_bf16 v[112:127], v[160:163], v[188:191], v[112:127]
    s_add_u32 s41, s40, 458752
    s_add_u32 m0, s42, 32768
    s_nop 0
    buffer_load_dwordx4 v2, s[24:27], s41 offen lds
    ds_read_b64_tr_b16 v[156:157], v9 offset:22528
    ds_read_b64_tr_b16 v[158:159], v9 offset:23040
    s_waitcnt lgkmcnt(8)
    v_mfma_f32_32x32x16_bf16 v[96:111], v[164:167], v[184:187], v[96:111]
    v_mfma_f32_32x32x16_bf16 v[128:143], v[164:167], v[188:191], v[128:143]
    s_add_u32 s41, s40, 487424
    s_add_u32 m0, s42, 33792
    s_nop 0
    buffer_load_dwordx4 v2, s[24:27], s41 offen lds
    s_waitcnt vmcnt(16)
    s_barrier
    ds_read_b64_tr_b16 v[160:161], v8 offset:24576
    ds_read_b64_tr_b16 v[162:163], v8 offset:25088
    s_waitcnt vmcnt(18)
    s_waitcnt lgkmcnt(8)
    v_mfma_f32_32x32x16_bf16 v[16:31], v[144:147], v[192:195], v[16:31]
    v_mfma_f32_32x32x16_bf16 v[48:63], v[144:147], v[196:199], v[48:63]
    buffer_load_dwordx4 v[232:235], v1, s[20:23], s34 offen offset:0
    ds_read_b64_tr_b16 v[164:165], v8 offset:28672
    ds_read_b64_tr_b16 v[166:167], v8 offset:29184
    s_waitcnt lgkmcnt(8)
    v_mfma_f32_32x32x16_bf16 v[32:47], v[148:151], v[192:195], v[32:47]
    v_mfma_f32_32x32x16_bf16 v[64:79], v[148:151], v[196:199], v[64:79]
    buffer_load_dwordx4 v[236:239], v1, s[20:23], s50 offen offset:0
    ds_read_b64_tr_b16 v[144:145], v9 offset:24576
    ds_read_b64_tr_b16 v[146:147], v9 offset:25088
    s_waitcnt lgkmcnt(8)
    v_mfma_f32_32x32x16_bf16 v[80:95], v[152:155], v[192:195], v[80:95]
    v_mfma_f32_32x32x16_bf16 v[112:127], v[152:155], v[196:199], v[112:127]
    buffer_load_dwordx4 v[240:243], v1, s[20:23], s34 offen offset:1024
    ds_read_b64_tr_b16 v[148:149], v9 offset:28672
    ds_read_b64_tr_b16 v[150:151], v9 offset:29184
    s_waitcnt lgkmcnt(8)
    v_mfma_f32_32x32x16_bf16 v[96:111], v[156:159], v[192:195], v[96:111]
    v_mfma_f32_32x32x16_bf16 v[128:143], v[156:159], v[196:199], v[128:143]
    buffer_load_dwordx4 v[244:247], v1, s[20:23], s50 offen offset:1024
    ds_read_b64_tr_b16 v[152:153], v8 offset:26624
    ds_read_b64_tr_b16 v[154:155], v8 offset:27136
    s_waitcnt vmcnt(18)
    s_waitcnt lgkmcnt(8)
    v_mfma_f32_32x32x16_bf16 v[16:31], v[160:163], v[200:203], v[16:31]
    v_mfma_f32_32x32x16_bf16 v[48:63], v[160:163], v[204:207], v[48:63]
    s_add_u32 s41, s40, 573440
    s_add_u32 m0, s42, 40960
    s_nop 0
    buffer_load_dwordx4 v2, s[24:27], s41 offen lds
    ds_read_b64_tr_b16 v[156:157], v8 offset:30720
    ds_read_b64_tr_b16 v[158:159], v8 offset:31232
    s_waitcnt lgkmcnt(8)
    v_mfma_f32_32x32x16_bf16 v[32:47], v[164:167], v[200:203], v[32:47]
    v_mfma_f32_32x32x16_bf16 v[64:79], v[164:167], v[204:207], v[64:79]
    s_add_u32 s41, s40, 602112
    s_add_u32 m0, s42, 41984
    s_nop 0
    buffer_load_dwordx4 v2, s[24:27], s41 offen lds
    ds_read_b64_tr_b16 v[160:161], v9 offset:26624
    ds_read_b64_tr_b16 v[162:163], v9 offset:27136
    s_waitcnt lgkmcnt(8)
    v_mfma_f32_32x32x16_bf16 v[80:95], v[144:147], v[200:203], v[80:95]
    v_mfma_f32_32x32x16_bf16 v[112:127], v[144:147], v[204:207], v[112:127]
    buffer_load_dwordx4 v[248:251], v1, s[20:23], s34 offen offset:2048
    ds_read_b64_tr_b16 v[164:165], v9 offset:30720
    ds_read_b64_tr_b16 v[166:167], v9 offset:31232
    s_waitcnt lgkmcnt(8)
    v_mfma_f32_32x32x16_bf16 v[96:111], v[148:151], v[200:203], v[96:111]
    v_mfma_f32_32x32x16_bf16 v[128:143], v[148:151], v[204:207], v[128:143]
    buffer_load_dwordx4 v[252:255], v1, s[20:23], s50 offen offset:2048
    s_waitcnt vmcnt(18)
    s_barrier
    ds_read_b64_tr_b16 v[144:145], v8 offset:32768
    ds_read_b64_tr_b16 v[146:147], v8 offset:33280
    s_waitcnt vmcnt(20)
    s_waitcnt lgkmcnt(8)
    v_mfma_f32_32x32x16_bf16 v[16:31], v[152:155], v[208:211], v[16:31]
    v_mfma_f32_32x32x16_bf16 v[48:63], v[152:155], v[212:215], v[48:63]
    buffer_load_dwordx4 v[168:171], v1, s[20:23], s34 offen offset:3072
    ds_read_b64_tr_b16 v[148:149], v8 offset:36864
    ds_read_b64_tr_b16 v[150:151], v8 offset:37376
    s_waitcnt lgkmcnt(8)
    v_mfma_f32_32x32x16_bf16 v[32:47], v[156:159], v[208:211], v[32:47]
    v_mfma_f32_32x32x16_bf16 v[64:79], v[156:159], v[212:215], v[64:79]
    buffer_load_dwordx4 v[172:175], v1, s[20:23], s50 offen offset:3072
    ds_read_b64_tr_b16 v[152:153], v9 offset:32768
    ds_read_b64_tr_b16 v[154:155], v9 offset:33280
    s_waitcnt lgkmcnt(8)
    v_mfma_f32_32x32x16_bf16 v[80:95], v[160:163], v[208:211], v[80:95]
    v_mfma_f32_32x32x16_bf16 v[112:127], v[160:163], v[212:215], v[112:127]
    s_add_u32 s41, s40, 688128
    s_add_u32 m0, s42, 49152
    s_nop 0
    buffer_load_dwordx4 v2, s[24:27], s41 offen lds
    ds_read_b64_tr_b16 v[156:157], v9 offset:36864
    ds_read_b64_tr_b16 v[158:159], v9 offset:37376
    s_waitcnt lgkmcnt(8)
    v_mfma_f32_32x32x16_bf16 v[96:111], v[164:167], v[208:211], v[96:111]
    v_mfma_f32_32x32x16_bf16 v[128:143], v[164:167], v[212:215], v[128:143]
    s_add_u32 s41, s40, 716800
    s_add_u32 m0, s42, 50176
    s_nop 0
    buffer_load_dwordx4 v2, s[24:27], s41 offen lds
    ds_read_b64_tr_b16 v[160:161], v8 offset:34816
    ds_read_b64_tr_b16 v[162:163], v8 offset:35328
    s_waitcnt vmcnt(20)
    s_waitcnt lgkmcnt(8)
    v_mfma_f32_32x32x16_bf16 v[16:31], v[144:147], v[216:219], v[16:31]
    v_mfma_f32_32x32x16_bf16 v[48:63], v[144:147], v[220:223], v[48:63]
    buffer_load_dwordx4 v[176:179], v1, s[20:23], s35 offen offset:0
    ds_read_b64_tr_b16 v[164:165], v8 offset:38912
    ds_read_b64_tr_b16 v[166:167], v8 offset:39424
    s_waitcnt lgkmcnt(8)
    v_mfma_f32_32x32x16_bf16 v[32:47], v[148:151], v[216:219], v[32:47]
    v_mfma_f32_32x32x16_bf16 v[64:79], v[148:151], v[220:223], v[64:79]
    buffer_load_dwordx4 v[180:183], v1, s[20:23], s51 offen offset:0
    ds_read_b64_tr_b16 v[144:145], v9 offset:34816
    ds_read_b64_tr_b16 v[146:147], v9 offset:35328
    s_waitcnt lgkmcnt(8)
    v_mfma_f32_32x32x16_bf16 v[80:95], v[152:155], v[216:219], v[80:95]
    v_mfma_f32_32x32x16_bf16 v[112:127], v[152:155], v[220:223], v[112:127]
    buffer_load_dwordx4 v[184:187], v1, s[20:23], s35 offen offset:1024
    ds_read_b64_tr_b16 v[148:149], v9 offset:38912
    ds_read_b64_tr_b16 v[150:151], v9 offset:39424
    s_waitcnt lgkmcnt(8)
    v_mfma_f32_32x32x16_bf16 v[96:111], v[156:159], v[216:219], v[96:111]
    v_mfma_f32_32x32x16_bf16 v[128:143], v[156:159], v[220:223], v[128:143]
    buffer_load_dwordx4 v[188:191], v1, s[20:23], s51 offen offset:1024
    s_waitcnt vmcnt(16)
    s_barrier
    ds_read_b64_tr_b16 v[152:153], v8 offset:40960
    ds_read_b64_tr_b16 v[154:155], v8 offset:41472
    s_waitcnt vmcnt(22)
    s_waitcnt lgkmcnt(8)
    v_mfma_f32_32x32x16_bf16 v[16:31], v[160:163], v[224:227], v[16:31]
    v_mfma_f32_32x32x16_bf16 v[48:63], v[160:163], v[228:231], v[48:63]
    s_add_u32 s41, s40, 802816
    s_add_u32 m0, s42, 0
    s_nop 0
    buffer_load_dwordx4 v2, s[24:27], s41 offen lds
    ds_read_b64_tr_b16 v[156:157], v8 offset:45056
    ds_read_b64_tr_b16 v[158:159], v8 offset:45568
    s_waitcnt lgkmcnt(8)
    v_mfma_f32_32x32x16_bf16 v[32:47], v[164:167], v[224:227], v[32:47]
    v_mfma_f32_32x32x16_bf16 v[64:79], v[164:167], v[228:231], v[64:79]
    s_add_u32 s41, s40, 831488
    s_add_u32 m0, s42, 1024
    s_nop 0
    buffer_load_dwordx4 v2, s[24:27], s41 offen lds
    ds_read_b64_tr_b16 v[160:161], v9 offset:40960
    ds_read_b64_tr_b16 v[162:163], v9 offset:41472
    s_waitcnt lgkmcnt(8)
    v_mfma_f32_32x32x16_bf16 v[80:95], v[144:147], v[224:227], v[80:95]
    v_mfma_f32_32x32x16_bf16 v[112:127], v[144:147], v[228:231], v[112:127]
    buffer_load_dwordx4 v[192:195], v1, s[20:23], s35 offen offset:2048
    ds_read_b64_tr_b16 v[164:165], v9 offset:45056
    ds_read_b64_tr_b16 v[166:167], v9 offset:45568
    s_waitcnt lgkmcnt(8)
    v_mfma_f32_32x32x16_bf16 v[96:111], v[148:151], v[224:227], v[96:111]
    v_mfma_f32_32x32x16_bf16 v[128:143], v[148:151], v[228:231], v[128:143]
    buffer_load_dwordx4 v[196:199], v1, s[20:23], s51 offen offset:2048
    ds_read_b64_tr_b16 v[144:145], v8 offset:43008
    ds_read_b64_tr_b16 v[146:147], v8 offset:43520
    s_waitcnt vmcnt(18)
    s_waitcnt lgkmcnt(8)
    v_mfma_f32_32x32x16_bf16 v[16:31], v[152:155], v[232:235], v[16:31]
    v_mfma_f32_32x32x16_bf16 v[48:63], v[152:155], v[236:239], v[48:63]
    buffer_load_dwordx4 v[200:203], v1, s[20:23], s35 offen offset:3072
    ds_read_b64_tr_b16 v[148:149], v8 offset:47104
    ds_read_b64_tr_b16 v[150:151], v8 offset:47616
    s_waitcnt lgkmcnt(8)
    v_mfma_f32_32x32x16_bf16 v[32:47], v[156:159], v[232:235], v[32:47]
    v_mfma_f32_32x32x16_bf16 v[64:79], v[156:159], v[236:239], v[64:79]
    buffer_load_dwordx4 v[204:207], v1, s[20:23], s51 offen offset:3072
    ds_read_b64_tr_b16 v[152:153], v9 offset:43008
    ds_read_b64_tr_b16 v[154:155], v9 offset:43520
    s_waitcnt lgkmcnt(8)
    v_mfma_f32_32x32x16_bf16 v[80:95], v[160:163], v[232:235], v[80:95]
    v_mfma_f32_32x32x16_bf16 v[112:127], v[160:163], v[236:239], v[112:127]
    s_add_u32 s41, s40, 917504
    s_add_u32 m0, s42, 8192
    s_nop 0
    buffer_load_dwordx4 v2, s[24:27], s41 offen lds
    ds_read_b64_tr_b16 v[156:157], v9 offset:47104
    ds_read_b64_tr_b16 v[158:159], v9 offset:47616
    s_waitcnt lgkmcnt(8)
    v_mfma_f32_32x32x16_bf16 v[96:111], v[164:167], v[232:235], v[96:111]
    v_mfma_f32_32x32x16_bf16 v[128:143], v[164:167], v[236:239], v[128:143]
    s_add_u32 s41, s40, 946176
    s_add_u32 m0, s42, 9216
    s_nop 0
    buffer_load_dwordx4 v2, s[24:27], s41 offen lds
    s_waitcnt vmcnt(18)
    s_barrier
    ds_read_b64_tr_b16 v[160:161], v8 offset:49152
    ds_read_b64_tr_b16 v[162:163], v8 offset:49664
    s_waitcnt vmcnt(20)
    s_waitcnt lgkmcnt(8)
    v_mfma_f32_32x32x16_bf16 v[16:31], v[144:147], v[240:243], v[16:31]
    v_mfma_f32_32x32x16_bf16 v[48:63], v[144:147], v[244:247], v[48:63]
    buffer_load_dwordx4 v[208:211], v1, s[20:23], s36 offen offset:0
    ds_read_b64_tr_b16 v[164:165], v8 offset:53248
    ds_read_b64_tr_b16 v[166:167], v8 offset:53760
    s_waitcnt lgkmcnt(8)
    v_mfma_f32_32x32x16_bf16 v[32:47], v[148:151], v[240:243], v[32:47]
    v_mfma_f32_32x32x16_bf16 v[64:79], v[148:151], v[244:247], v[64:79]
    buffer_load_dwordx4 v[212:215], v1, s[20:23], s52 offen offset:0
    ds_read_b64_tr_b16 v[144:145], v9 offset:49152
    ds_read_b64_tr_b16 v[146:147], v9 offset:49664
    s_waitcnt lgkmcnt(8)
    v_mfma_f32_32x32x16_bf16 v[80:95], v[152:155], v[240:243], v[80:95]
    v_mfma_f32_32x32x16_bf16 v[112:127], v[152:155], v[244:247], v[112:127]
    buffer_load_dwordx4 v[216:219], v1, s[20:23], s36 offen offset:1024
    ds_read_b64_tr_b16 v[148:149], v9 offset:53248
    ds_read_b64_tr_b16 v[150:151], v9 offset:53760
    s_waitcnt lgkmcnt(8)
    v_mfma_f32_32x32x16_bf16 v[96:111], v[156:159], v[240:243], v[96:111]
    v_mfma_f32_32x32x16_bf16 v[128:143], v[156:159], v[244:247], v[128:143]
    buffer_load_dwordx4 v[220:223], v1, s[20:23], s52 offen offset:1024
    ds_read_b64_tr_b16 v[152:153], v8 offset:51200
    ds_read_b64_tr_b16 v[154:155], v8 offset:51712
    s_waitcnt vmcnt(20)
    s_waitcnt lgkmcnt(8)
    v_mfma_f32_32x32x16_bf16 v[16:31], v[160:163], v[248:251], v[16:31]
    v_mfma_f32_32x32x16_bf16 v[48:63], v[160:163], v[252:255], v[48:63]
    s_add_u32 s41, s40, 1032192
    s_add_u32 m0, s42, 16384
    s_nop 0
    buffer_load_dwordx4 v2, s[24:27], s41 offen lds
    ds_read_b64_tr_b16 v[156:157], v8 offset:55296
    ds_read_b64_tr_b16 v[158:159], v8 offset:55808
    s_waitcnt lgkmcnt(8)
    v_mfma_f32_32x32x16_bf16 v[32:47], v[164:167], v[248:251], v[32:47]
    v_mfma_f32_32x32x16_bf16 v[64:79], v[164:167], v[252:255], v[64:79]
    s_add_u32 s41, s40, 1060864
    s_add_u32 m0, s42, 17408
    s_nop 0
    buffer_load_dwordx4 v2, s[24:27], s41 offen lds
    ds_read_b64_tr_b16 v[160:161], v9 offset:51200
    ds_read_b64_tr_b16 v[162:163], v9 offset:51712
    s_waitcnt lgkmcnt(8)
    v_mfma_f32_32x32x16_bf16 v[80:95], v[144:147], v[248:251], v[80:95]
    v_mfma_f32_32x32x16_bf16 v[112:127], v[144:147], v[252:255], v[112:127]
    buffer_load_dwordx4 v[224:227], v1, s[20:23], s36 offen offset:2048
    ds_read_b64_tr_b16 v[164:165], v9 offset:55296
    ds_read_b64_tr_b16 v[166:167], v9 offset:55808
    s_waitcnt lgkmcnt(8)
    v_mfma_f32_32x32x16_bf16 v[96:111], v[148:151], v[248:251], v[96:111]
    v_mfma_f32_32x32x16_bf16 v[128:143], v[148:151], v[252:255], v[128:143]
    buffer_load_dwordx4 v[228:231], v1, s[20:23], s52 offen offset:2048
    s_waitcnt vmcnt(20)
    s_barrier
    ds_read_b64_tr_b16 v[144:145], v8 offset:57344
    ds_read_b64_tr_b16 v[146:147], v8 offset:57856
    s_waitcnt vmcnt(22)
    s_waitcnt lgkmcnt(8)
    v_mfma_f32_32x32x16_bf16 v[16:31], v[152:155], v[168:171], v[16:31]
    v_mfma_f32_32x32x16_bf16 v[48:63], v[152:155], v[172:175], v[48:63]
    buffer_load_dwordx4 v[232:235], v1, s[20:23], s36 offen offset:3072
    ds_read_b64_tr_b16 v[148:149], v8 offset:61440
    ds_read_b64_tr_b16 v[150:151], v8 offset:61952
    s_waitcnt lgkmcnt(8)
    v_mfma_f32_32x32x16_bf16 v[32:47], v[156:159], v[168:171], v[32:47]
    v_mfma_f32_32x32x16_bf16 v[64:79], v[156:159], v[172:175], v[64:79]
    buffer_load_dwordx4 v[236:239], v1, s[20:23], s52 offen offset:3072
    ds_read_b64_tr_b16 v[152:153], v9 offset:57344
    ds_read_b64_tr_b16 v[154:155], v9 offset:57856
    s_waitcnt lgkmcnt(8)
    v_mfma_f32_32x32x16_bf16 v[80:95], v[160:163], v[168:171], v[80:95]
    v_mfma_f32_32x32x16_bf16 v[112:127], v[160:163], v[172:175], v[112:127]
    ds_read_b64_tr_b16 v[156:157], v9 offset:61440
    ds_read_b64_tr_b16 v[158:159], v9 offset:61952
    s_waitcnt lgkmcnt(8)
    v_mfma_f32_32x32x16_bf16 v[96:111], v[164:167], v[168:171], v[96:111]
    v_mfma_f32_32x32x16_bf16 v[128:143], v[164:167], v[172:175], v[128:143]
    ds_read_b64_tr_b16 v[160:161], v8 offset:59392
    ds_read_b64_tr_b16 v[162:163], v8 offset:59904
    s_waitcnt vmcnt(20)
    s_waitcnt lgkmcnt(8)
    v_mfma_f32_32x32x16_bf16 v[16:31], v[144:147], v[176:179], v[16:31]
    v_mfma_f32_32x32x16_bf16 v[48:63], v[144:147], v[180:183], v[48:63]
    s_add_u32 s41, s40, 1146880
    s_add_u32 m0, s42, 24576
    s_nop 0
    buffer_load_dwordx4 v2, s[24:27], s41 offen lds
    ds_read_b64_tr_b16 v[164:165], v8 offset:63488
    ds_read_b64_tr_b16 v[166:167], v8 offset:64000
    s_waitcnt lgkmcnt(8)
    v_mfma_f32_32x32x16_bf16 v[32:47], v[148:151], v[176:179], v[32:47]
    v_mfma_f32_32x32x16_bf16 v[64:79], v[148:151], v[180:183], v[64:79]
    s_add_u32 s41, s40, 1175552
    s_add_u32 m0, s42, 25600
    s_nop 0
    buffer_load_dwordx4 v2, s[24:27], s41 offen lds
    ds_read_b64_tr_b16 v[144:145], v9 offset:59392
    ds_read_b64_tr_b16 v[146:147], v9 offset:59904
    s_waitcnt lgkmcnt(8)
    v_mfma_f32_32x32x16_bf16 v[80:95], v[152:155], v[176:179], v[80:95]
    v_mfma_f32_32x32x16_bf16 v[112:127], v[152:155], v[180:183], v[112:127]
    buffer_load_dwordx4 v[240:243], v1, s[20:23], s37 offen offset:0
    ds_read_b64_tr_b16 v[148:149], v9 offset:63488
    ds_read_b64_tr_b16 v[150:151], v9 offset:64000
    s_waitcnt lgkmcnt(8)
    v_mfma_f32_32x32x16_bf16 v[96:111], v[156:159], v[176:179], v[96:111]
    v_mfma_f32_32x32x16_bf16 v[128:143], v[156:159], v[180:183], v[128:143]
    buffer_load_dwordx4 v[244:247], v1, s[20:23], s53 offen offset:0
    s_waitcnt vmcnt(20)
    s_barrier
    ds_read_b64_tr_b16 v[152:153], v8 offset:8192
    ds_read_b64_tr_b16 v[154:155], v8 offset:8704
    s_waitcnt vmcnt(22)
    s_waitcnt lgkmcnt(8)
    v_mfma_f32_32x32x16_bf16 v[16:31], v[160:163], v[184:187], v[16:31]
    v_mfma_f32_32x32x16_bf16 v[48:63], v[160:163], v[188:191], v[48:63]
    buffer_load_dwordx4 v[248:251], v1, s[20:23], s37 offen offset:1024
    ds_read_b64_tr_b16 v[156:157], v8 offset:12288
    ds_read_b64_tr_b16 v[158:159], v8 offset:12800
    s_waitcnt lgkmcnt(8)
    v_mfma_f32_32x32x16_bf16 v[32:47], v[164:167], v[184:187], v[32:47]
    v_mfma_f32_32x32x16_bf16 v[64:79], v[164:167], v[188:191], v[64:79]
    buffer_load_dwordx4 v[252:255], v1, s[20:23], s53 offen offset:1024
    ds_read_b64_tr_b16 v[160:161], v9 offset:8192
    ds_read_b64_tr_b16 v[162:163], v9 offset:8704
    s_waitcnt lgkmcnt(8)
    v_mfma_f32_32x32x16_bf16 v[80:95], v[144:147], v[184:187], v[80:95]
    v_mfma_f32_32x32x16_bf16 v[112:127], v[144:147], v[188:191], v[112:127]
    ds_read_b64_tr_b16 v[164:165], v9 offset:12288
    ds_read_b64_tr_b16 v[166:167], v9 offset:12800
    s_waitcnt lgkmcnt(8)
    v_mfma_f32_32x32x16_bf16 v[96:111], v[148:151], v[184:187], v[96:111]
    v_mfma_f32_32x32x16_bf16 v[128:143], v[148:151], v[188:191], v[128:143]
    ds_read_b64_tr_b16 v[144:145], v8 offset:10240
    ds_read_b64_tr_b16 v[146:147], v8 offset:10752
    s_waitcnt vmcnt(20)
    s_waitcnt lgkmcnt(8)
    v_mfma_f32_32x32x16_bf16 v[16:31], v[152:155], v[192:195], v[16:31]
    v_mfma_f32_32x32x16_bf16 v[48:63], v[152:155], v[196:199], v[48:63]
    s_add_u32 s41, s40, 1261568
    s_add_u32 m0, s42, 32768
    s_nop 0
    buffer_load_dwordx4 v2, s[24:27], s41 offen lds
    ds_read_b64_tr_b16 v[148:149], v8 offset:14336
    ds_read_b64_tr_b16 v[150:151], v8 offset:14848
    s_waitcnt lgkmcnt(8)
    v_mfma_f32_32x32x16_bf16 v[32:47], v[156:159], v[192:195], v[32:47]
    v_mfma_f32_32x32x16_bf16 v[64:79], v[156:159], v[196:199], v[64:79]
    s_add_u32 s41, s40, 1290240
    s_add_u32 m0, s42, 33792
    s_nop 0
    buffer_load_dwordx4 v2, s[24:27], s41 offen lds
    ds_read_b64_tr_b16 v[152:153], v9 offset:10240
    ds_read_b64_tr_b16 v[154:155], v9 offset:10752
    s_waitcnt lgkmcnt(8)
    v_mfma_f32_32x32x16_bf16 v[80:95], v[160:163], v[192:195], v[80:95]
    v_mfma_f32_32x32x16_bf16 v[112:127], v[160:163], v[196:199], v[112:127]
    buffer_load_dwordx4 v[168:171], v1, s[20:23], s37 offen offset:2048
    ds_read_b64_tr_b16 v[156:157], v9 offset:14336
    ds_read_b64_tr_b16 v[158:159], v9 offset:14848
    s_waitcnt lgkmcnt(8)
    v_mfma_f32_32x32x16_bf16 v[96:111], v[164:167], v[192:195], v[96:111]
    v_mfma_f32_32x32x16_bf16 v[128:143], v[164:167], v[196:199], v[128:143]
    buffer_load_dwordx4 v[172:175], v1, s[20:23], s53 offen offset:2048
    s_waitcnt vmcnt(20)
    s_barrier
    ds_read_b64_tr_b16 v[160:161], v8 offset:16384
    ds_read_b64_tr_b16 v[162:163], v8 offset:16896
    s_waitcnt vmcnt(22)
    s_waitcnt lgkmcnt(8)
    v_mfma_f32_32x32x16_bf16 v[16:31], v[144:147], v[200:203], v[16:31]
    v_mfma_f32_32x32x16_bf16 v[48:63], v[144:147], v[204:207], v[48:63]
    buffer_load_dwordx4 v[176:179], v1, s[20:23], s37 offen offset:3072
    ds_read_b64_tr_b16 v[164:165], v8 offset:20480
    ds_read_b64_tr_b16 v[166:167], v8 offset:20992
    s_waitcnt lgkmcnt(8)
    v_mfma_f32_32x32x16_bf16 v[32:47], v[148:151], v[200:203], v[32:47]
    v_mfma_f32_32x32x16_bf16 v[64:79], v[148:151], v[204:207], v[64:79]
    buffer_load_dwordx4 v[180:183], v1, s[20:23], s53 offen offset:3072
    ds_read_b64_tr_b16 v[144:145], v9 offset:16384
    ds_read_b64_tr_b16 v[146:147], v9 offset:16896
    s_waitcnt lgkmcnt(8)
    v_mfma_f32_32x32x16_bf16 v[80:95], v[152:155], v[200:203], v[80:95]
    v_mfma_f32_32x32x16_bf16 v[112:127], v[152:155], v[204:207], v[112:127]
    ds_read_b64_tr_b16 v[148:149], v9 offset:20480
    ds_read_b64_tr_b16 v[150:151], v9 offset:20992
    s_waitcnt lgkmcnt(8)
    v_mfma_f32_32x32x16_bf16 v[96:111], v[156:159], v[200:203], v[96:111]
    v_mfma_f32_32x32x16_bf16 v[128:143], v[156:159], v[204:207], v[128:143]
    ds_read_b64_tr_b16 v[152:153], v8 offset:18432
    ds_read_b64_tr_b16 v[154:155], v8 offset:18944
    s_waitcnt vmcnt(20)
    s_waitcnt lgkmcnt(8)
    v_mfma_f32_32x32x16_bf16 v[16:31], v[160:163], v[208:211], v[16:31]
    v_mfma_f32_32x32x16_bf16 v[48:63], v[160:163], v[212:215], v[48:63]
    s_add_u32 s41, s40, 1376256
    s_add_u32 m0, s42, 40960
    s_nop 0
    buffer_load_dwordx4 v2, s[24:27], s41 offen lds
    ds_read_b64_tr_b16 v[156:157], v8 offset:22528
    ds_read_b64_tr_b16 v[158:159], v8 offset:23040
    s_waitcnt lgkmcnt(8)
    v_mfma_f32_32x32x16_bf16 v[32:47], v[164:167], v[208:211], v[32:47]
    v_mfma_f32_32x32x16_bf16 v[64:79], v[164:167], v[212:215], v[64:79]
    s_add_u32 s41, s40, 1404928
    s_add_u32 m0, s42, 41984
    s_nop 0
    buffer_load_dwordx4 v2, s[24:27], s41 offen lds
    ds_read_b64_tr_b16 v[160:161], v9 offset:18432
    ds_read_b64_tr_b16 v[162:163], v9 offset:18944
    s_waitcnt lgkmcnt(8)
    v_mfma_f32_32x32x16_bf16 v[80:95], v[144:147], v[208:211], v[80:95]
    v_mfma_f32_32x32x16_bf16 v[112:127], v[144:147], v[212:215], v[112:127]
    buffer_load_dwordx4 v[184:187], v1, s[20:23], s38 offen offset:0
    ds_read_b64_tr_b16 v[164:165], v9 offset:22528
    ds_read_b64_tr_b16 v[166:167], v9 offset:23040
    s_waitcnt lgkmcnt(8)
    v_mfma_f32_32x32x16_bf16 v[96:111], v[148:151], v[208:211], v[96:111]
    v_mfma_f32_32x32x16_bf16 v[128:143], v[148:151], v[212:215], v[128:143]
    buffer_load_dwordx4 v[188:191], v1, s[20:23], s54 offen offset:0
    s_waitcnt vmcnt(20)
    s_barrier
    ds_read_b64_tr_b16 v[144:145], v8 offset:24576
    ds_read_b64_tr_b16 v[146:147], v8 offset:25088
    s_waitcnt vmcnt(22)
    s_waitcnt lgkmcnt(8)
    v_mfma_f32_32x32x16_bf16 v[16:31], v[152:155], v[216:219], v[16:31]
    v_mfma_f32_32x32x16_bf16 v[48:63], v[152:155], v[220:223], v[48:63]
    buffer_load_dwordx4 v[192:195], v1, s[20:23], s38 offen offset:1024
    ds_read_b64_tr_b16 v[148:149], v8 offset:28672
    ds_read_b64_tr_b16 v[150:151], v8 offset:29184
    s_waitcnt lgkmcnt(8)
    v_mfma_f32_32x32x16_bf16 v[32:47], v[156:159], v[216:219], v[32:47]
    v_mfma_f32_32x32x16_bf16 v[64:79], v[156:159], v[220:223], v[64:79]
    buffer_load_dwordx4 v[196:199], v1, s[20:23], s54 offen offset:1024
    ds_read_b64_tr_b16 v[152:153], v9 offset:24576
    ds_read_b64_tr_b16 v[154:155], v9 offset:25088
    s_waitcnt lgkmcnt(8)
    v_mfma_f32_32x32x16_bf16 v[80:95], v[160:163], v[216:219], v[80:95]
    v_mfma_f32_32x32x16_bf16 v[112:127], v[160:163], v[220:223], v[112:127]
    s_add_u32 s41, s40, 1490944
    s_add_u32 m0, s42, 49152
    s_nop 0
    buffer_load_dwordx4 v2, s[24:27], s41 offen lds
    ds_read_b64_tr_b16 v[156:157], v9 offset:28672
    ds_read_b64_tr_b16 v[158:159], v9 offset:29184
    s_waitcnt lgkmcnt(8)
    v_mfma_f32_32x32x16_bf16 v[96:111], v[164:167], v[216:219], v[96:111]
    v_mfma_f32_32x32x16_bf16 v[128:143], v[164:167], v[220:223], v[128:143]
    s_add_u32 s41, s40, 1519616
    s_add_u32 m0, s42, 50176
    s_nop 0
    buffer_load_dwordx4 v2, s[24:27], s41 offen lds
    ds_read_b64_tr_b16 v[160:161], v8 offset:26624
    ds_read_b64_tr_b16 v[162:163], v8 offset:27136
    s_waitcnt vmcnt(22)
    s_waitcnt lgkmcnt(8)
    v_mfma_f32_32x32x16_bf16 v[16:31], v[144:147], v[224:227], v[16:31]
    v_mfma_f32_32x32x16_bf16 v[48:63], v[144:147], v[228:231], v[48:63]
    buffer_load_dwordx4 v[200:203], v1, s[20:23], s38 offen offset:2048
    ds_read_b64_tr_b16 v[164:165], v8 offset:30720
    ds_read_b64_tr_b16 v[166:167], v8 offset:31232
    s_waitcnt lgkmcnt(8)
    v_mfma_f32_32x32x16_bf16 v[32:47], v[148:151], v[224:227], v[32:47]
    v_mfma_f32_32x32x16_bf16 v[64:79], v[148:151], v[228:231], v[64:79]
    buffer_load_dwordx4 v[204:207], v1, s[20:23], s54 offen offset:2048
    ds_read_b64_tr_b16 v[144:145], v9 offset:26624
    ds_read_b64_tr_b16 v[146:147], v9 offset:27136
    s_waitcnt lgkmcnt(8)
    v_mfma_f32_32x32x16_bf16 v[80:95], v[152:155], v[224:227], v[80:95]
    v_mfma_f32_32x32x16_bf16 v[112:127], v[152:155], v[228:231], v[112:127]
    buffer_load_dwordx4 v[208:211], v1, s[20:23], s38 offen offset:3072
    ds_read_b64_tr_b16 v[148:149], v9 offset:30720
    ds_read_b64_tr_b16 v[150:151], v9 offset:31232
    s_waitcnt lgkmcnt(8)
    v_mfma_f32_32x32x16_bf16 v[96:111], v[156:159], v[224:227], v[96:111]
    v_mfma_f32_32x32x16_bf16 v[128:143], v[156:159], v[228:231], v[128:143]
    buffer_load_dwordx4 v[212:215], v1, s[20:23], s54 offen offset:3072
    s_waitcnt vmcnt(22)
    s_barrier
    ds_read_b64_tr_b16 v[152:153], v8 offset:32768
    ds_read_b64_tr_b16 v[154:155], v8 offset:33280
    s_waitcnt vmcnt(24)
    s_waitcnt lgkmcnt(8)
    v_mfma_f32_32x32x16_bf16 v[16:31], v[160:163], v[232:235], v[16:31]
    v_mfma_f32_32x32x16_bf16 v[48:63], v[160:163], v[236:239], v[48:63]
    s_add_u32 s41, s40, 1605632
    s_add_u32 m0, s42, 0
    s_nop 0
    buffer_load_dwordx4 v2, s[24:27], s41 offen lds
    ds_read_b64_tr_b16 v[156:157], v8 offset:36864
    ds_read_b64_tr_b16 v[158:159], v8 offset:37376
    s_waitcnt lgkmcnt(8)
    v_mfma_f32_32x32x16_bf16 v[32:47], v[164:167], v[232:235], v[32:47]
    v_mfma_f32_32x32x16_bf16 v[64:79], v[164:167], v[236:239], v[64:79]
    s_add_u32 s41, s40, 1634304
    s_add_u32 m0, s42, 1024
    s_nop 0
    buffer_load_dwordx4 v2, s[24:27], s41 offen lds
    ds_read_b64_tr_b16 v[160:161], v9 offset:32768
    ds_read_b64_tr_b16 v[162:163], v9 offset:33280
    s_waitcnt lgkmcnt(8)
    v_mfma_f32_32x32x16_bf16 v[80:95], v[144:147], v[232:235], v[80:95]
    v_mfma_f32_32x32x16_bf16 v[112:127], v[144:147], v[236:239], v[112:127]
    buffer_load_dwordx4 v[216:219], v1, s[20:23], s39 offen offset:0
    ds_read_b64_tr_b16 v[164:165], v9 offset:36864
    ds_read_b64_tr_b16 v[166:167], v9 offset:37376
    s_waitcnt lgkmcnt(8)
    v_mfma_f32_32x32x16_bf16 v[96:111], v[148:151], v[232:235], v[96:111]
    v_mfma_f32_32x32x16_bf16 v[128:143], v[148:151], v[236:239], v[128:143]
    buffer_load_dwordx4 v[220:223], v1, s[20:23], s55 offen offset:0
    ds_read_b64_tr_b16 v[144:145], v8 offset:34816
    ds_read_b64_tr_b16 v[146:147], v8 offset:35328
    s_waitcnt vmcnt(24)
    s_waitcnt lgkmcnt(8)
    v_mfma_f32_32x32x16_bf16 v[16:31], v[152:155], v[240:243], v[16:31]
    v_mfma_f32_32x32x16_bf16 v[48:63], v[152:155], v[244:247], v[48:63]
    buffer_load_dwordx4 v[224:227], v1, s[20:23], s39 offen offset:1024
    buffer_load_dwordx4 v[228:231], v1, s[20:23], s55 offen offset:1024
    ds_read_b64_tr_b16 v[148:149], v8 offset:38912
    ds_read_b64_tr_b16 v[150:151], v8 offset:39424
    s_waitcnt lgkmcnt(8)
    v_mfma_f32_32x32x16_bf16 v[32:47], v[156:159], v[240:243], v[32:47]
    v_mfma_f32_32x32x16_bf16 v[64:79], v[156:159], v[244:247], v[64:79]
    s_add_u32 s41, s40, 1720320
    s_add_u32 m0, s42, 8192
    s_nop 0
    buffer_load_dwordx4 v2, s[24:27], s41 offen lds
    s_add_u32 s41, s40, 1748992
    s_add_u32 m0, s42, 9216
    s_nop 0
    buffer_load_dwordx4 v2, s[24:27], s41 offen lds
    ds_read_b64_tr_b16 v[152:153], v9 offset:34816
    ds_read_b64_tr_b16 v[154:155], v9 offset:35328
    s_waitcnt lgkmcnt(8)
    v_mfma_f32_32x32x16_bf16 v[80:95], v[160:163], v[240:243], v[80:95]
    v_mfma_f32_32x32x16_bf16 v[112:127], v[160:163], v[244:247], v[112:127]
    buffer_load_dwordx4 v[232:235], v1, s[20:23], s39 offen offset:2048
    buffer_load_dwordx4 v[236:239], v1, s[20:23], s55 offen offset:2048
    ds_read_b64_tr_b16 v[156:157], v9 offset:38912
    ds_read_b64_tr_b16 v[158:159], v9 offset:39424
    s_waitcnt lgkmcnt(8)
    v_mfma_f32_32x32x16_bf16 v[96:111], v[164:167], v[240:243], v[96:111]
    v_mfma_f32_32x32x16_bf16 v[128:143], v[164:167], v[244:247], v[128:143]
    buffer_load_dwordx4 v[240:243], v1, s[20:23], s39 offen offset:3072
    buffer_load_dwordx4 v[244:247], v1, s[20:23], s55 offen offset:3072
    s_waitcnt vmcnt(28)
    s_barrier
    ds_read_b64_tr_b16 v[160:161], v8 offset:40960
    ds_read_b64_tr_b16 v[162:163], v8 offset:41472
    s_waitcnt vmcnt(30)
    s_waitcnt lgkmcnt(8)
    v_mfma_f32_32x32x16_bf16 v[16:31], v[144:147], v[248:251], v[16:31]
    v_mfma_f32_32x32x16_bf16 v[48:63], v[144:147], v[252:255], v[48:63]
    ds_read_b64_tr_b16 v[164:165], v8 offset:45056
    ds_read_b64_tr_b16 v[166:167], v8 offset:45568
    s_waitcnt lgkmcnt(8)
    v_mfma_f32_32x32x16_bf16 v[32:47], v[148:151], v[248:251], v[32:47]
    v_mfma_f32_32x32x16_bf16 v[64:79], v[148:151], v[252:255], v[64:79]
    ds_read_b64_tr_b16 v[144:145], v9 offset:40960
    ds_read_b64_tr_b16 v[146:147], v9 offset:41472
    s_waitcnt lgkmcnt(8)
    v_mfma_f32_32x32x16_bf16 v[80:95], v[152:155], v[248:251], v[80:95]
    v_mfma_f32_32x32x16_bf16 v[112:127], v[152:155], v[252:255], v[112:127]
    ds_read_b64_tr_b16 v[148:149], v9 offset:45056
    ds_read_b64_tr_b16 v[150:151], v9 offset:45568
    s_waitcnt lgkmcnt(8)
    v_mfma_f32_32x32x16_bf16 v[96:111], v[156:159], v[248:251], v[96:111]
    v_mfma_f32_32x32x16_bf16 v[128:143], v[156:159], v[252:255], v[128:143]
    ds_read_b64_tr_b16 v[152:153], v8 offset:43008
    ds_read_b64_tr_b16 v[154:155], v8 offset:43520
    s_waitcnt vmcnt(26)
    s_waitcnt lgkmcnt(8)
    v_mfma_f32_32x32x16_bf16 v[16:31], v[160:163], v[168:171], v[16:31]
    v_mfma_f32_32x32x16_bf16 v[48:63], v[160:163], v[172:175], v[48:63]
    ds_read_b64_tr_b16 v[156:157], v8 offset:47104
    ds_read_b64_tr_b16 v[158:159], v8 offset:47616
    s_waitcnt lgkmcnt(8)
    v_mfma_f32_32x32x16_bf16 v[32:47], v[164:167], v[168:171], v[32:47]
    v_mfma_f32_32x32x16_bf16 v[64:79], v[164:167], v[172:175], v[64:79]
    ds_read_b64_tr_b16 v[160:161], v9 offset:43008
    ds_read_b64_tr_b16 v[162:163], v9 offset:43520
    s_waitcnt lgkmcnt(8)
    v_mfma_f32_32x32x16_bf16 v[80:95], v[144:147], v[168:171], v[80:95]
    v_mfma_f32_32x32x16_bf16 v[112:127], v[144:147], v[172:175], v[112:127]
    ds_read_b64_tr_b16 v[164:165], v9 offset:47104
    ds_read_b64_tr_b16 v[166:167], v9 offset:47616
    s_waitcnt lgkmcnt(8)
    v_mfma_f32_32x32x16_bf16 v[96:111], v[148:151], v[168:171], v[96:111]
    v_mfma_f32_32x32x16_bf16 v[128:143], v[148:151], v[172:175], v[128:143]
    s_waitcnt vmcnt(22)
    s_barrier
    ds_read_b64_tr_b16 v[144:145], v8 offset:49152
    ds_read_b64_tr_b16 v[146:147], v8 offset:49664
    s_waitcnt vmcnt(24)
    s_waitcnt lgkmcnt(8)
    v_mfma_f32_32x32x16_bf16 v[16:31], v[152:155], v[176:179], v[16:31]
    v_mfma_f32_32x32x16_bf16 v[48:63], v[152:155], v[180:183], v[48:63]
    ds_read_b64_tr_b16 v[148:149], v8 offset:53248
    ds_read_b64_tr_b16 v[150:151], v8 offset:53760
    s_waitcnt lgkmcnt(8)
    v_mfma_f32_32x32x16_bf16 v[32:47], v[156:159], v[176:179], v[32:47]
    v_mfma_f32_32x32x16_bf16 v[64:79], v[156:159], v[180:183], v[64:79]
    ds_read_b64_tr_b16 v[152:153], v8 offset:51200
    ds_read_b64_tr_b16 v[154:155], v8 offset:51712
    s_waitcnt lgkmcnt(8)
    v_mfma_f32_32x32x16_bf16 v[80:95], v[160:163], v[176:179], v[80:95]
    v_mfma_f32_32x32x16_bf16 v[112:127], v[160:163], v[180:183], v[112:127]
    ds_read_b64_tr_b16 v[156:157], v8 offset:55296
    ds_read_b64_tr_b16 v[158:159], v8 offset:55808
    s_waitcnt lgkmcnt(8)
    v_mfma_f32_32x32x16_bf16 v[96:111], v[164:167], v[176:179], v[96:111]
    v_mfma_f32_32x32x16_bf16 v[128:143], v[164:167], v[180:183], v[128:143]
    s_waitcnt vmcnt(16)
    s_barrier
    ds_read_b64_tr_b16 v[160:161], v8 offset:57344
    ds_read_b64_tr_b16 v[162:163], v8 offset:57856
    s_waitcnt vmcnt(20)
    s_waitcnt lgkmcnt(8)
    v_mfma_f32_32x32x16_bf16 v[16:31], v[144:147], v[184:187], v[16:31]
    v_mfma_f32_32x32x16_bf16 v[48:63], v[144:147], v[188:191], v[48:63]
    ds_read_b64_tr_b16 v[164:165], v8 offset:61440
    ds_read_b64_tr_b16 v[166:167], v8 offset:61952
    s_waitcnt lgkmcnt(8)
    v_mfma_f32_32x32x16_bf16 v[32:47], v[148:151], v[184:187], v[32:47]
    v_mfma_f32_32x32x16_bf16 v[64:79], v[148:151], v[188:191], v[64:79]
    ds_read_b64_tr_b16 v[144:145], v8 offset:59392
    ds_read_b64_tr_b16 v[146:147], v8 offset:59904
    s_waitcnt vmcnt(18)
    s_waitcnt lgkmcnt(8)
    v_mfma_f32_32x32x16_bf16 v[16:31], v[152:155], v[192:195], v[16:31]
    v_mfma_f32_32x32x16_bf16 v[48:63], v[152:155], v[196:199], v[48:63]
    ds_read_b64_tr_b16 v[148:149], v8 offset:63488
    ds_read_b64_tr_b16 v[150:151], v8 offset:64000
    s_waitcnt lgkmcnt(8)
    v_mfma_f32_32x32x16_bf16 v[32:47], v[156:159], v[192:195], v[32:47]
    v_mfma_f32_32x32x16_bf16 v[64:79], v[156:159], v[196:199], v[64:79]
    s_waitcnt vmcnt(10)
    s_barrier
    ds_read_b64_tr_b16 v[152:153], v8 offset:8192
    ds_read_b64_tr_b16 v[154:155], v8 offset:8704
    s_waitcnt vmcnt(14)
    s_waitcnt lgkmcnt(8)
    v_mfma_f32_32x32x16_bf16 v[16:31], v[160:163], v[200:203], v[16:31]
    v_mfma_f32_32x32x16_bf16 v[48:63], v[160:163], v[204:207], v[48:63]
    v_lshlrev_b32 v249, 2, v0
    s_nop 0
    buffer_load_dword v248, v249, s[84:87], s4 offen sc1
    ds_read_b64_tr_b16 v[156:157], v8 offset:12288
    ds_read_b64_tr_b16 v[158:159], v8 offset:12800
    s_waitcnt lgkmcnt(8)
    v_mfma_f32_32x32x16_bf16 v[32:47], v[164:167], v[200:203], v[32:47]
    v_mfma_f32_32x32x16_bf16 v[64:79], v[164:167], v[204:207], v[64:79]
    ds_read_b64_tr_b16 v[160:161], v8 offset:10240
    ds_read_b64_tr_b16 v[162:163], v8 offset:10752
    s_waitcnt vmcnt(13)
    s_waitcnt lgkmcnt(8)
    v_mfma_f32_32x32x16_bf16 v[16:31], v[144:147], v[208:211], v[16:31]
    v_mfma_f32_32x32x16_bf16 v[48:63], v[144:147], v[212:215], v[48:63]
    ds_read_b64_tr_b16 v[164:165], v8 offset:14336
    ds_read_b64_tr_b16 v[166:167], v8 offset:14848
    s_waitcnt lgkmcnt(8)
    v_mfma_f32_32x32x16_bf16 v[32:47], v[148:151], v[208:211], v[32:47]
    v_mfma_f32_32x32x16_bf16 v[64:79], v[148:151], v[212:215], v[64:79]
    s_waitcnt vmcnt(5)
    s_barrier
    ds_read_b64_tr_b16 v[144:145], v8 offset:16384
    ds_read_b64_tr_b16 v[146:147], v8 offset:16896
    s_waitcnt vmcnt(9)
    s_waitcnt lgkmcnt(8)
    v_mfma_f32_32x32x16_bf16 v[16:31], v[152:155], v[216:219], v[16:31]
    v_mfma_f32_32x32x16_bf16 v[48:63], v[152:155], v[220:223], v[48:63]
    ds_read_b64_tr_b16 v[148:149], v8 offset:20480
    ds_read_b64_tr_b16 v[150:151], v8 offset:20992
    s_waitcnt lgkmcnt(8)
    v_mfma_f32_32x32x16_bf16 v[32:47], v[156:159], v[216:219], v[32:47]
    v_mfma_f32_32x32x16_bf16 v[64:79], v[156:159], v[220:223], v[64:79]
    ds_read_b64_tr_b16 v[152:153], v8 offset:18432
    ds_read_b64_tr_b16 v[154:155], v8 offset:18944
    s_waitcnt vmcnt(7)
    s_waitcnt lgkmcnt(8)
    v_mfma_f32_32x32x16_bf16 v[16:31], v[160:163], v[224:227], v[16:31]
    v_mfma_f32_32x32x16_bf16 v[48:63], v[160:163], v[228:231], v[48:63]
    ds_read_b64_tr_b16 v[156:157], v8 offset:22528
    ds_read_b64_tr_b16 v[158:159], v8 offset:23040
    s_waitcnt lgkmcnt(8)
    v_mfma_f32_32x32x16_bf16 v[32:47], v[164:167], v[224:227], v[32:47]
    v_mfma_f32_32x32x16_bf16 v[64:79], v[164:167], v[228:231], v[64:79]
    ds_read_b64_tr_b16 v[160:161], v9 offset:49152
    ds_read_b64_tr_b16 v[162:163], v9 offset:49664
    s_waitcnt vmcnt(3)
    s_waitcnt lgkmcnt(8)
    v_mfma_f32_32x32x16_bf16 v[16:31], v[144:147], v[232:235], v[16:31]
    v_mfma_f32_32x32x16_bf16 v[48:63], v[144:147], v[236:239], v[48:63]
    s_waitcnt vmcnt(0)
    v_cmp_ne_u32_e64 s[14:15], 0, v248
    s_nop 1
    s_cmp_eq_u32 s14, 0x0fffffff
    s_cbranch_scc1 Lpd_wf
    s_mov_b32 s9, 0
Lp_wf:
    buffer_load_dword v248, v249, s[84:87], s4 offen sc1
    s_waitcnt vmcnt(0)
    v_cmp_ne_u32_e64 s[14:15], 0, v248
    s_nop 1
    s_cmp_eq_u32 s14, 0x0fffffff
    s_cbranch_scc1 Lpd_wf
    s_add_u32 s9, s9, 1
    s_cmp_ge_u32 s9, 60000
    s_cbranch_scc1 Lpd_wf
    s_sleep 4
    s_branch Lp_wf
Lpd_wf:

    s_add_u32 s14, s19, 0
    buffer_load_dwordx4 v[248:251], v4, s[84:87], s14 offen
    buffer_load_dwordx4 v[252:255], v5, s[84:87], s14 offen
    ds_read_b64_tr_b16 v[164:165], v9 offset:53248
    ds_read_b64_tr_b16 v[166:167], v9 offset:53760
    s_waitcnt lgkmcnt(8)
    v_mfma_f32_32x32x16_bf16 v[32:47], v[148:151], v[232:235], v[32:47]
    v_mfma_f32_32x32x16_bf16 v[64:79], v[148:151], v[236:239], v[64:79]
    s_add_u32 s14, s19, 1024
    buffer_load_dwordx4 v[168:171], v4, s[84:87], s14 offen
    buffer_load_dwordx4 v[172:175], v5, s[84:87], s14 offen
    ds_read_b64_tr_b16 v[144:145], v9 offset:51200
    ds_read_b64_tr_b16 v[146:147], v9 offset:51712
    s_waitcnt vmcnt(5)
    s_waitcnt lgkmcnt(8)
    v_mfma_f32_32x32x16_bf16 v[16:31], v[152:155], v[240:243], v[16:31]
    v_mfma_f32_32x32x16_bf16 v[48:63], v[152:155], v[244:247], v[48:63]
    s_add_u32 s14, s19, 4096
    buffer_load_dwordx4 v[176:179], v4, s[84:87], s14 offen
    buffer_load_dwordx4 v[180:183], v5, s[84:87], s14 offen
    ds_read_b64_tr_b16 v[148:149], v9 offset:55296
    ds_read_b64_tr_b16 v[150:151], v9 offset:55808
    s_waitcnt lgkmcnt(8)
    v_mfma_f32_32x32x16_bf16 v[32:47], v[156:159], v[240:243], v[32:47]
    v_mfma_f32_32x32x16_bf16 v[64:79], v[156:159], v[244:247], v[64:79]
    ds_read_b64_tr_b16 v[152:153], v9 offset:57344
    ds_read_b64_tr_b16 v[154:155], v9 offset:57856
    s_waitcnt lgkmcnt(8)
    v_mfma_f32_32x32x16_bf16 v[80:95], v[160:163], v[184:187], v[80:95]
    v_mfma_f32_32x32x16_bf16 v[112:127], v[160:163], v[188:191], v[112:127]
    ds_read_b64_tr_b16 v[156:157], v9 offset:61440
    ds_read_b64_tr_b16 v[158:159], v9 offset:61952
    s_waitcnt lgkmcnt(8)
    v_mfma_f32_32x32x16_bf16 v[96:111], v[164:167], v[184:187], v[96:111]
    v_cvt_pk_bf16_f32 v12, v16, v17
    v_cvt_pk_bf16_f32 v13, v18, v19
    v_cvt_pk_bf16_f32 v14, v20, v21
    v_cvt_pk_bf16_f32 v15, v22, v23
    v_subrev_u32 v12, s46, v12
    v_subrev_u32 v13, s46, v13
    v_subrev_u32 v14, s46, v14
    v_subrev_u32 v15, s46, v15
    v_mfma_f32_32x32x16_bf16 v[128:143], v[164:167], v[188:191], v[128:143]
    v_or3_b32 v11, v12, v13, v14
    v_or_b32 v11, v11, v15
    v_and_b32 v11, 0x70007000, v11
    v_cmp_ne_u32_e64 s[90:91], 0, v11
    v_and_b32 v7, s98, v12
    v_lshlrev_b32_sdwa v16, 1, v7 dst_sel:DWORD dst_unused:UNUSED_PAD src0_sel:DWORD src1_sel:WORD_0
    v_lshlrev_b32_sdwa v17, 1, v7 dst_sel:DWORD dst_unused:UNUSED_PAD src0_sel:DWORD src1_sel:WORD_1
    v_and_b32 v7, s98, v13
    s_add_u32 s14, s19, 5120
    buffer_load_dwordx4 v[184:187], v4, s[84:87], s14 offen
    buffer_load_dwordx4 v[188:191], v5, s[84:87], s14 offen
    ds_read_b64_tr_b16 v[160:161], v9 offset:59392
    ds_read_b64_tr_b16 v[162:163], v9 offset:59904
    s_waitcnt lgkmcnt(8)
    v_mfma_f32_32x32x16_bf16 v[80:95], v[144:147], v[192:195], v[80:95]
    v_lshlrev_b32_sdwa v18, 1, v7 dst_sel:DWORD dst_unused:UNUSED_PAD src0_sel:DWORD src1_sel:WORD_0
    v_lshlrev_b32_sdwa v19, 1, v7 dst_sel:DWORD dst_unused:UNUSED_PAD src0_sel:DWORD src1_sel:WORD_1
    v_and_b32 v7, s98, v14
    v_lshlrev_b32_sdwa v20, 1, v7 dst_sel:DWORD dst_unused:UNUSED_PAD src0_sel:DWORD src1_sel:WORD_0
    v_lshlrev_b32_sdwa v21, 1, v7 dst_sel:DWORD dst_unused:UNUSED_PAD src0_sel:DWORD src1_sel:WORD_1
    v_and_b32 v7, s98, v15
    v_lshlrev_b32_sdwa v22, 1, v7 dst_sel:DWORD dst_unused:UNUSED_PAD src0_sel:DWORD src1_sel:WORD_0
    v_lshlrev_b32_sdwa v23, 1, v7 dst_sel:DWORD dst_unused:UNUSED_PAD src0_sel:DWORD src1_sel:WORD_1
    v_mfma_f32_32x32x16_bf16 v[112:127], v[144:147], v[196:199], v[112:127]
    ds_read_u16_d16_hi v16, v16
    ds_read_u16_d16_hi v17, v17
    ds_read_u16_d16_hi v18, v18
    ds_read_u16_d16_hi v19, v19
    ds_read_u16_d16_hi v20, v20
    ds_read_u16_d16_hi v21, v21
    ds_read_u16_d16_hi v22, v22
    ds_read_u16_d16_hi v23, v23
    ds_read_b64_tr_b16 v[164:165], v9 offset:63488
    ds_read_b64_tr_b16 v[166:167], v9 offset:64000
    s_waitcnt lgkmcnt(15)
    v_mfma_f32_32x32x16_bf16 v[96:111], v[148:151], v[192:195], v[96:111]
    v_cvt_pk_bf16_f32 v1, v24, v25
    v_cvt_pk_bf16_f32 v2, v26, v27
    v_cvt_pk_bf16_f32 v3, v28, v29
    v_cvt_pk_bf16_f32 v6, v30, v31
    v_subrev_u32 v1, s46, v1
    v_subrev_u32 v2, s46, v2
    v_subrev_u32 v3, s46, v3
    v_subrev_u32 v6, s46, v6
    v_mfma_f32_32x32x16_bf16 v[128:143], v[148:151], v[196:199], v[128:143]
    v_or3_b32 v11, v1, v2, v3
    v_or_b32 v11, v11, v6
    v_and_b32 v11, 0x70007000, v11
    v_cmp_ne_u32_e64 s[92:93], 0, v11
    v_and_b32 v7, s98, v1
    v_lshlrev_b32_sdwa v24, 1, v7 dst_sel:DWORD dst_unused:UNUSED_PAD src0_sel:DWORD src1_sel:WORD_0
    v_lshlrev_b32_sdwa v25, 1, v7 dst_sel:DWORD dst_unused:UNUSED_PAD src0_sel:DWORD src1_sel:WORD_1
    v_and_b32 v7, s98, v2
    s_add_u32 s14, s19, 8192
    buffer_load_dwordx4 v[192:195], v4, s[84:87], s14 offen
    buffer_load_dwordx4 v[196:199], v5, s[84:87], s14 offen
    ds_read_b64_tr_b16 v[144:145], v9 offset:8192
    ds_read_b64_tr_b16 v[146:147], v9 offset:8704
    s_waitcnt lgkmcnt(15)
    v_mfma_f32_32x32x16_bf16 v[80:95], v[152:155], v[200:203], v[80:95]
    v_lshlrev_b32_sdwa v26, 1, v7 dst_sel:DWORD dst_unused:UNUSED_PAD src0_sel:DWORD src1_sel:WORD_0
    v_lshlrev_b32_sdwa v27, 1, v7 dst_sel:DWORD dst_unused:UNUSED_PAD src0_sel:DWORD src1_sel:WORD_1
    v_and_b32 v7, s98, v3
    v_lshlrev_b32_sdwa v28, 1, v7 dst_sel:DWORD dst_unused:UNUSED_PAD src0_sel:DWORD src1_sel:WORD_0
    v_lshlrev_b32_sdwa v29, 1, v7 dst_sel:DWORD dst_unused:UNUSED_PAD src0_sel:DWORD src1_sel:WORD_1
    v_and_b32 v7, s98, v6
    v_lshlrev_b32_sdwa v30, 1, v7 dst_sel:DWORD dst_unused:UNUSED_PAD src0_sel:DWORD src1_sel:WORD_0
    v_lshlrev_b32_sdwa v31, 1, v7 dst_sel:DWORD dst_unused:UNUSED_PAD src0_sel:DWORD src1_sel:WORD_1
    v_mfma_f32_32x32x16_bf16 v[112:127], v[152:155], v[204:207], v[112:127]
    ds_read_u16_d16_hi v24, v24
    ds_read_u16_d16_hi v25, v25
    ds_read_u16_d16_hi v26, v26
    ds_read_u16_d16_hi v27, v27
    ds_read_u16_d16_hi v28, v28
    ds_read_u16_d16_hi v29, v29
    ds_read_u16_d16_hi v30, v30
    ds_read_u16_d16_hi v31, v31
    ds_read_b64_tr_b16 v[148:149], v9 offset:12288
    ds_read_b64_tr_b16 v[150:151], v9 offset:12800
    s_waitcnt lgkmcnt(15)
    v_mfma_f32_32x32x16_bf16 v[96:111], v[156:159], v[200:203], v[96:111]
    v_cvt_pk_bf16_f32 v32, 0, v32
    v_cvt_pk_bf16_f32 v33, 0, v33
    v_cvt_pk_bf16_f32 v34, 0, v34
    v_cvt_pk_bf16_f32 v35, 0, v35
    v_cvt_pk_bf16_f32 v36, 0, v36
    v_cvt_pk_bf16_f32 v37, 0, v37
    v_cvt_pk_bf16_f32 v38, 0, v38
    v_cvt_pk_bf16_f32 v39, 0, v39
    v_mfma_f32_32x32x16_bf16 v[128:143], v[156:159], v[204:207], v[128:143]
    s_waitcnt lgkmcnt(14)
    s_cmp_lg_u64 s[90:91], 0
    s_cbranch_scc1 Lslow_0
Lback_0:
    v_mul_f32_e32 v32, v16, v32
    v_mul_f32_e32 v33, v17, v33
    v_mul_f32_e32 v34, v18, v34
    v_mul_f32_e32 v35, v19, v35
    v_mul_f32_e32 v36, v20, v36
    v_mul_f32_e32 v37, v21, v37
    v_mul_f32_e32 v38, v22, v38
    s_add_u32 s14, s19, 9216
    buffer_load_dwordx4 v[200:203], v4, s[84:87], s14 offen
    buffer_load_dwordx4 v[204:207], v5, s[84:87], s14 offen
    ds_read_b64_tr_b16 v[152:153], v9 offset:10240
    ds_read_b64_tr_b16 v[154:155], v9 offset:10752
    s_waitcnt lgkmcnt(15)
    v_mfma_f32_32x32x16_bf16 v[80:95], v[160:163], v[208:211], v[80:95]
    v_mul_f32_e32 v39, v23, v39
    v_cvt_pk_bf16_f32 v16, v32, v33
    v_cvt_pk_bf16_f32 v17, v34, v35
    v_cvt_pk_bf16_f32 v18, v36, v37
    v_cvt_pk_bf16_f32 v19, v38, v39
    buffer_store_dwordx4 v[16:19], v4, s[28:31], s12 offen offset:0 sc1
    v_cvt_pk_bf16_f32 v12, v48, v49
    v_cvt_pk_bf16_f32 v13, v50, v51
    v_mfma_f32_32x32x16_bf16 v[112:127], v[160:163], v[212:215], v[112:127]
    v_cvt_pk_bf16_f32 v14, v52, v53
    v_cvt_pk_bf16_f32 v15, v54, v55
    v_subrev_u32 v12, s46, v12
    v_subrev_u32 v13, s46, v13
    v_subrev_u32 v14, s46, v14
    v_subrev_u32 v15, s46, v15
    v_or3_b32 v11, v12, v13, v14
    v_or_b32 v11, v11, v15
    ds_read_b64_tr_b16 v[156:157], v9 offset:14336
    ds_read_b64_tr_b16 v[158:159], v9 offset:14848
    s_waitcnt lgkmcnt(15)
    v_mfma_f32_32x32x16_bf16 v[96:111], v[164:167], v[208:211], v[96:111]
    v_and_b32 v11, 0x70007000, v11
    v_cmp_ne_u32_e64 s[90:91], 0, v11
    v_and_b32 v7, s98, v12
    v_lshlrev_b32_sdwa v48, 1, v7 dst_sel:DWORD dst_unused:UNUSED_PAD src0_sel:DWORD src1_sel:WORD_0
    v_lshlrev_b32_sdwa v49, 1, v7 dst_sel:DWORD dst_unused:UNUSED_PAD src0_sel:DWORD src1_sel:WORD_1
    v_and_b32 v7, s98, v13
    v_lshlrev_b32_sdwa v50, 1, v7 dst_sel:DWORD dst_unused:UNUSED_PAD src0_sel:DWORD src1_sel:WORD_0
    v_lshlrev_b32_sdwa v51, 1, v7 dst_sel:DWORD dst_unused:UNUSED_PAD src0_sel:DWORD src1_sel:WORD_1
    v_mfma_f32_32x32x16_bf16 v[128:143], v[164:167], v[212:215], v[128:143]
    v_and_b32 v7, s98, v14
    v_lshlrev_b32_sdwa v52, 1, v7 dst_sel:DWORD dst_unused:UNUSED_PAD src0_sel:DWORD src1_sel:WORD_0
    v_lshlrev_b32_sdwa v53, 1, v7 dst_sel:DWORD dst_unused:UNUSED_PAD src0_sel:DWORD src1_sel:WORD_1
    v_and_b32 v7, s98, v15
    v_lshlrev_b32_sdwa v54, 1, v7 dst_sel:DWORD dst_unused:UNUSED_PAD src0_sel:DWORD src1_sel:WORD_0
    v_lshlrev_b32_sdwa v55, 1, v7 dst_sel:DWORD dst_unused:UNUSED_PAD src0_sel:DWORD src1_sel:WORD_1
    ds_read_u16_d16_hi v48, v48
    ds_read_u16_d16_hi v49, v49
    s_add_u32 s14, s19, 12288
    buffer_load_dwordx4 v[208:211], v4, s[84:87], s14 offen
    buffer_load_dwordx4 v[212:215], v5, s[84:87], s14 offen
    ds_read_b64_tr_b16 v[160:161], v9 offset:16384
    ds_read_b64_tr_b16 v[162:163], v9 offset:16896
    s_waitcnt lgkmcnt(15)
    v_mfma_f32_32x32x16_bf16 v[80:95], v[144:147], v[216:219], v[80:95]
    ds_read_u16_d16_hi v50, v50
    ds_read_u16_d16_hi v51, v51
    ds_read_u16_d16_hi v52, v52
    ds_read_u16_d16_hi v53, v53
    ds_read_u16_d16_hi v54, v54
    ds_read_u16_d16_hi v55, v55
    v_cvt_pk_bf16_f32 v40, 0, v40
    v_cvt_pk_bf16_f32 v41, 0, v41
    v_mfma_f32_32x32x16_bf16 v[112:127], v[144:147], v[220:223], v[112:127]
    v_cvt_pk_bf16_f32 v42, 0, v42
    v_cvt_pk_bf16_f32 v43, 0, v43
    v_cvt_pk_bf16_f32 v44, 0, v44
    v_cvt_pk_bf16_f32 v45, 0, v45
    v_cvt_pk_bf16_f32 v46, 0, v46
    v_cvt_pk_bf16_f32 v47, 0, v47
    s_waitcnt lgkmcnt(15)
    s_cmp_lg_u64 s[92:93], 0
    s_cbranch_scc1 Lslow_1
Lback_1:
    v_mul_f32_e32 v40, v24, v40
    ds_read_b64_tr_b16 v[164:165], v9 offset:20480
    ds_read_b64_tr_b16 v[166:167], v9 offset:20992
    s_waitcnt lgkmcnt(15)
    v_mfma_f32_32x32x16_bf16 v[96:111], v[148:151], v[216:219], v[96:111]
    v_mul_f32_e32 v41, v25, v41
    v_mul_f32_e32 v42, v26, v42
    v_mul_f32_e32 v43, v27, v43
    v_mul_f32_e32 v44, v28, v44
    v_mul_f32_e32 v45, v29, v45
    v_mul_f32_e32 v46, v30, v46
    v_mul_f32_e32 v47, v31, v47
    v_cvt_pk_bf16_f32 v24, v40, v41
    v_mfma_f32_32x32x16_bf16 v[128:143], v[148:151], v[220:223], v[128:143]
    v_cvt_pk_bf16_f32 v25, v42, v43
    v_cvt_pk_bf16_f32 v26, v44, v45
    v_cvt_pk_bf16_f32 v27, v46, v47
    buffer_store_dwordx4 v[24:27], v4, s[28:31], s12 offen offset:1024 sc1
    v_cvt_pk_bf16_f32 v1, v56, v57
    v_cvt_pk_bf16_f32 v2, v58, v59
    v_cvt_pk_bf16_f32 v3, v60, v61
    v_cvt_pk_bf16_f32 v6, v62, v63
    s_add_u32 s14, s19, 13312
    buffer_load_dwordx4 v[216:219], v4, s[84:87], s14 offen
    buffer_load_dwordx4 v[220:223], v5, s[84:87], s14 offen
    ds_read_b64_tr_b16 v[144:145], v9 offset:18432
    ds_read_b64_tr_b16 v[146:147], v9 offset:18944
    s_waitcnt lgkmcnt(15)
    v_mfma_f32_32x32x16_bf16 v[80:95], v[152:155], v[224:227], v[80:95]
    v_subrev_u32 v1, s46, v1
    v_subrev_u32 v2, s46, v2
    v_subrev_u32 v3, s46, v3
    v_subrev_u32 v6, s46, v6
    v_or3_b32 v11, v1, v2, v3
    v_or_b32 v11, v11, v6
    v_and_b32 v11, 0x70007000, v11
    v_cmp_ne_u32_e64 s[92:93], 0, v11
    v_mfma_f32_32x32x16_bf16 v[112:127], v[152:155], v[228:231], v[112:127]
    v_and_b32 v7, s98, v1
    v_lshlrev_b32_sdwa v56, 1, v7 dst_sel:DWORD dst_unused:UNUSED_PAD src0_sel:DWORD src1_sel:WORD_0
    v_lshlrev_b32_sdwa v57, 1, v7 dst_sel:DWORD dst_unused:UNUSED_PAD src0_sel:DWORD src1_sel:WORD_1
    v_and_b32 v7, s98, v2
    v_lshlrev_b32_sdwa v58, 1, v7 dst_sel:DWORD dst_unused:UNUSED_PAD src0_sel:DWORD src1_sel:WORD_0
    v_lshlrev_b32_sdwa v59, 1, v7 dst_sel:DWORD dst_unused:UNUSED_PAD src0_sel:DWORD src1_sel:WORD_1
    v_and_b32 v7, s98, v3
    v_lshlrev_b32_sdwa v60, 1, v7 dst_sel:DWORD dst_unused:UNUSED_PAD src0_sel:DWORD src1_sel:WORD_0
    ds_read_b64_tr_b16 v[148:149], v9 offset:22528
    ds_read_b64_tr_b16 v[150:151], v9 offset:23040
    s_waitcnt lgkmcnt(15)
    v_mfma_f32_32x32x16_bf16 v[96:111], v[156:159], v[224:227], v[96:111]
    v_lshlrev_b32_sdwa v61, 1, v7 dst_sel:DWORD dst_unused:UNUSED_PAD src0_sel:DWORD src1_sel:WORD_1
    v_and_b32 v7, s98, v6
    v_lshlrev_b32_sdwa v62, 1, v7 dst_sel:DWORD dst_unused:UNUSED_PAD src0_sel:DWORD src1_sel:WORD_0
    v_lshlrev_b32_sdwa v63, 1, v7 dst_sel:DWORD dst_unused:UNUSED_PAD src0_sel:DWORD src1_sel:WORD_1
    ds_read_u16_d16_hi v56, v56
    ds_read_u16_d16_hi v57, v57
    ds_read_u16_d16_hi v58, v58
    ds_read_u16_d16_hi v59, v59
    v_mfma_f32_32x32x16_bf16 v[128:143], v[156:159], v[228:231], v[128:143]
    ds_read_u16_d16_hi v60, v60
    ds_read_u16_d16_hi v61, v61
    ds_read_u16_d16_hi v62, v62
    ds_read_u16_d16_hi v63, v63
    v_cvt_pk_bf16_f32 v64, 0, v64
    v_cvt_pk_bf16_f32 v65, 0, v65
    v_cvt_pk_bf16_f32 v66, 0, v66
    v_cvt_pk_bf16_f32 v67, 0, v67
    s_add_u32 s14, s19, 16384
    buffer_load_dwordx4 v[224:227], v4, s[84:87], s14 offen
    buffer_load_dwordx4 v[228:231], v5, s[84:87], s14 offen
    s_waitcnt lgkmcnt(15)
    v_mfma_f32_32x32x16_bf16 v[80:95], v[160:163], v[232:235], v[80:95]
    v_cvt_pk_bf16_f32 v68, 0, v68
    v_cvt_pk_bf16_f32 v69, 0, v69
    v_cvt_pk_bf16_f32 v70, 0, v70
    v_cvt_pk_bf16_f32 v71, 0, v71
    s_waitcnt lgkmcnt(14)
    s_cmp_lg_u64 s[90:91], 0
    s_cbranch_scc1 Lslow_2
Lback_2:
    v_mul_f32_e32 v64, v48, v64
    v_mul_f32_e32 v65, v49, v65
    v_mul_f32_e32 v66, v50, v66
    v_mfma_f32_32x32x16_bf16 v[112:127], v[160:163], v[236:239], v[112:127]
    v_mul_f32_e32 v67, v51, v67
    v_mul_f32_e32 v68, v52, v68
    v_mul_f32_e32 v69, v53, v69
    v_mul_f32_e32 v70, v54, v70
    v_mul_f32_e32 v71, v55, v71
    v_cvt_pk_bf16_f32 v48, v64, v65
    v_cvt_pk_bf16_f32 v49, v66, v67
    v_cvt_pk_bf16_f32 v50, v68, v69
    s_waitcnt lgkmcnt(12)
    v_mfma_f32_32x32x16_bf16 v[96:111], v[164:167], v[232:235], v[96:111]
    v_cvt_pk_bf16_f32 v51, v70, v71
    buffer_store_dwordx4 v[48:51], v4, s[28:31], s13 offen offset:0 sc1
    v_cvt_pk_bf16_f32 v72, 0, v72
    v_cvt_pk_bf16_f32 v73, 0, v73
    v_cvt_pk_bf16_f32 v74, 0, v74
    v_cvt_pk_bf16_f32 v75, 0, v75
    v_cvt_pk_bf16_f32 v76, 0, v76
    v_cvt_pk_bf16_f32 v77, 0, v77
    v_mfma_f32_32x32x16_bf16 v[128:143], v[164:167], v[236:239], v[128:143]
    v_cvt_pk_bf16_f32 v78, 0, v78
    v_cvt_pk_bf16_f32 v79, 0, v79
    s_waitcnt lgkmcnt(0)
    s_cmp_lg_u64 s[92:93], 0
    s_cbranch_scc1 Lslow_3
Lback_3:
    v_mul_f32_e32 v72, v56, v72
    v_mul_f32_e32 v73, v57, v73
    v_mul_f32_e32 v74, v58, v74
    v_mul_f32_e32 v75, v59, v75
    v_mul_f32_e32 v76, v60, v76
    s_add_u32 s14, s19, 17408
    buffer_load_dwordx4 v[232:235], v4, s[84:87], s14 offen
    buffer_load_dwordx4 v[236:239], v5, s[84:87], s14 offen
    s_waitcnt lgkmcnt(10)
    v_mfma_f32_32x32x16_bf16 v[80:95], v[144:147], v[240:243], v[80:95]
    v_mul_f32_e32 v77, v61, v77
    v_mul_f32_e32 v78, v62, v78
    v_mul_f32_e32 v79, v63, v79
    v_cvt_pk_bf16_f32 v56, v72, v73
    v_cvt_pk_bf16_f32 v57, v74, v75
    v_cvt_pk_bf16_f32 v58, v76, v77
    v_cvt_pk_bf16_f32 v59, v78, v79
    buffer_store_dwordx4 v[56:59], v4, s[28:31], s13 offen offset:1024 sc1
    v_mfma_f32_32x32x16_bf16 v[112:127], v[144:147], v[244:247], v[112:127]
    s_waitcnt lgkmcnt(8)
    v_mfma_f32_32x32x16_bf16 v[96:111], v[148:151], v[240:243], v[96:111]
    v_mfma_f32_32x32x16_bf16 v[128:143], v[148:151], v[244:247], v[128:143]
    s_add_u32 s14, s19, 20480
    buffer_load_dwordx4 v[240:243], v4, s[84:87], s14 offen
    buffer_load_dwordx4 v[244:247], v5, s[84:87], s14 offen
    s_add_u32 s32, s16, 0x1400000
    s_addc_u32 s33, s17, 0
    s_and_b32 s33, s33, 0xffff
    s_mov_b32 s34, 0x18000
    s_mov_b32 s35, 0x20000
    s_add_u32 s36, s16, 0x1000000
    s_addc_u32 s37, s17, 0
    s_and_b32 s37, s37, 0xffff
    s_mov_b32 s38, 0x200000
    s_mov_b32 s39, 0x20000
    s_mov_b32 s48, s56
    s_and_b32 s49, s57, 0xffff
    s_mov_b32 s50, 0x200000
    s_mov_b32 s51, 0x20000
    s_mov_b32 s52, s58
    s_and_b32 s53, s59, 0xffff
    s_mov_b32 s54, 0x200000
    s_mov_b32 s55, 0x20000
    s_barrier
    s_add_u32 s14, s19, 21504
    buffer_load_dwordx4 v[160:163], v4, s[84:87], s14 offen
    s_add_u32 s14, s19, 21504
    buffer_load_dwordx4 v[164:167], v5, s[84:87], s14 offen
    s_add_u32 s14, s19, 24576
    s_add_u32 m0, s61, 0
    s_nop 0
    buffer_load_dwordx4 v4, s[84:87], s14 offen lds
    s_add_u32 s14, s19, 24576
    s_add_u32 m0, s61, 1024
    s_nop 0
    buffer_load_dwordx4 v5, s[84:87], s14 offen lds
    s_add_u32 s14, s19, 25600
    s_add_u32 m0, s61, 2048
    s_nop 0
    buffer_load_dwordx4 v4, s[84:87], s14 offen lds
    s_add_u32 s14, s19, 25600
    s_add_u32 m0, s61, 3072
    s_nop 0
    buffer_load_dwordx4 v5, s[84:87], s14 offen lds
    s_add_u32 s14, s19, 2048
    s_add_u32 m0, s61, 4096
    s_nop 0
    buffer_load_dwordx4 v4, s[84:87], s14 offen lds
    s_add_u32 s14, s19, 2048
    s_add_u32 m0, s61, 5120
    s_nop 0
    buffer_load_dwordx4 v5, s[84:87], s14 offen lds
    s_add_u32 s14, s19, 3072
    s_add_u32 m0, s61, 6144
    s_nop 0
    buffer_load_dwordx4 v4, s[84:87], s14 offen lds
    s_add_u32 s14, s19, 3072
    s_add_u32 m0, s61, 7168
    s_nop 0
    buffer_load_dwordx4 v5, s[84:87], s14 offen lds
    s_add_u32 s14, s19, 6144
    s_add_u32 m0, s8, 0
    s_nop 0
    buffer_load_dwordx4 v4, s[84:87], s14 offen lds
    s_add_u32 s14, s19, 6144
    s_add_u32 m0, s8, 1024
    s_nop 0
    buffer_load_dwordx4 v5, s[84:87], s14 offen lds
    s_add_u32 s14, s19, 7168
    s_add_u32 m0, s8, 2048
    s_nop 0
    buffer_load_dwordx4 v4, s[84:87], s14 offen lds
    s_add_u32 s14, s19, 7168
    s_add_u32 m0, s8, 3072
    s_nop 0
    buffer_load_dwordx4 v5, s[84:87], s14 offen lds
    s_add_u32 s14, s19, 10240
    s_add_u32 m0, s8, 4096
    s_nop 0
    buffer_load_dwordx4 v4, s[84:87], s14 offen lds
    s_add_u32 s14, s19, 10240
    s_add_u32 m0, s8, 5120
    s_nop 0
    buffer_load_dwordx4 v5, s[84:87], s14 offen lds
    s_add_u32 s14, s19, 11264
    s_add_u32 m0, s8, 6144
    s_nop 0
    buffer_load_dwordx4 v4, s[84:87], s14 offen lds
    s_add_u32 s14, s19, 11264
    s_add_u32 m0, s8, 7168
    s_nop 0
    buffer_load_dwordx4 v5, s[84:87], s14 offen lds
    v_cvt_pk_bf16_f32 v12, v80, v81
    v_cvt_pk_bf16_f32 v13, v82, v83
    v_cvt_pk_bf16_f32 v14, v84, v85
    v_cvt_pk_bf16_f32 v15, v86, v87
    v_subrev_u32 v12, s46, v12
    v_subrev_u32 v13, s46, v13
    v_subrev_u32 v14, s46, v14
    v_subrev_u32 v15, s46, v15
    v_or3_b32 v11, v12, v13, v14
    v_or_b32 v11, v11, v15
    v_and_b32 v11, 0x70007000, v11
    v_cmp_ne_u32_e64 s[90:91], 0, v11
    v_and_b32 v7, s98, v12
    v_lshlrev_b32_sdwa v80, 1, v7 dst_sel:DWORD dst_unused:UNUSED_PAD src0_sel:DWORD src1_sel:WORD_0
    v_lshlrev_b32_sdwa v81, 1, v7 dst_sel:DWORD dst_unused:UNUSED_PAD src0_sel:DWORD src1_sel:WORD_1
    v_and_b32 v7, s98, v13
    v_lshlrev_b32_sdwa v82, 1, v7 dst_sel:DWORD dst_unused:UNUSED_PAD src0_sel:DWORD src1_sel:WORD_0
    v_lshlrev_b32_sdwa v83, 1, v7 dst_sel:DWORD dst_unused:UNUSED_PAD src0_sel:DWORD src1_sel:WORD_1
    v_and_b32 v7, s98, v14
    v_lshlrev_b32_sdwa v84, 1, v7 dst_sel:DWORD dst_unused:UNUSED_PAD src0_sel:DWORD src1_sel:WORD_0
    v_lshlrev_b32_sdwa v85, 1, v7 dst_sel:DWORD dst_unused:UNUSED_PAD src0_sel:DWORD src1_sel:WORD_1
    v_and_b32 v7, s98, v15
    v_lshlrev_b32_sdwa v86, 1, v7 dst_sel:DWORD dst_unused:UNUSED_PAD src0_sel:DWORD src1_sel:WORD_0
    v_lshlrev_b32_sdwa v87, 1, v7 dst_sel:DWORD dst_unused:UNUSED_PAD src0_sel:DWORD src1_sel:WORD_1
    ds_read_u16_d16_hi v80, v80
    ds_read_u16_d16_hi v81, v81
    ds_read_u16_d16_hi v82, v82
    ds_read_u16_d16_hi v83, v83
    ds_read_u16_d16_hi v84, v84
    ds_read_u16_d16_hi v85, v85
    ds_read_u16_d16_hi v86, v86
    ds_read_u16_d16_hi v87, v87
    v_cvt_pk_bf16_f32 v1, v88, v89
    v_cvt_pk_bf16_f32 v2, v90, v91
    v_cvt_pk_bf16_f32 v3, v92, v93
    v_cvt_pk_bf16_f32 v6, v94, v95
    v_subrev_u32 v1, s46, v1
    v_subrev_u32 v2, s46, v2
    v_subrev_u32 v3, s46, v3
    v_subrev_u32 v6, s46, v6
    v_or3_b32 v11, v1, v2, v3
    v_or_b32 v11, v11, v6
    v_and_b32 v11, 0x70007000, v11
    v_cmp_ne_u32_e64 s[92:93], 0, v11
    v_and_b32 v7, s98, v1
    v_lshlrev_b32_sdwa v88, 1, v7 dst_sel:DWORD dst_unused:UNUSED_PAD src0_sel:DWORD src1_sel:WORD_0
    v_lshlrev_b32_sdwa v89, 1, v7 dst_sel:DWORD dst_unused:UNUSED_PAD src0_sel:DWORD src1_sel:WORD_1
    v_and_b32 v7, s98, v2
    v_lshlrev_b32_sdwa v90, 1, v7 dst_sel:DWORD dst_unused:UNUSED_PAD src0_sel:DWORD src1_sel:WORD_0
    v_lshlrev_b32_sdwa v91, 1, v7 dst_sel:DWORD dst_unused:UNUSED_PAD src0_sel:DWORD src1_sel:WORD_1
    v_and_b32 v7, s98, v3
    v_lshlrev_b32_sdwa v92, 1, v7 dst_sel:DWORD dst_unused:UNUSED_PAD src0_sel:DWORD src1_sel:WORD_0
    v_lshlrev_b32_sdwa v93, 1, v7 dst_sel:DWORD dst_unused:UNUSED_PAD src0_sel:DWORD src1_sel:WORD_1
    v_and_b32 v7, s98, v6
    v_lshlrev_b32_sdwa v94, 1, v7 dst_sel:DWORD dst_unused:UNUSED_PAD src0_sel:DWORD src1_sel:WORD_0
    v_lshlrev_b32_sdwa v95, 1, v7 dst_sel:DWORD dst_unused:UNUSED_PAD src0_sel:DWORD src1_sel:WORD_1
    ds_read_u16_d16_hi v88, v88
    ds_read_u16_d16_hi v89, v89
    ds_read_u16_d16_hi v90, v90
    ds_read_u16_d16_hi v91, v91
    ds_read_u16_d16_hi v92, v92
    ds_read_u16_d16_hi v93, v93
    ds_read_u16_d16_hi v94, v94
    ds_read_u16_d16_hi v95, v95
    v_cvt_pk_bf16_f32 v96, 0, v96
    v_cvt_pk_bf16_f32 v97, 0, v97
    v_cvt_pk_bf16_f32 v98, 0, v98
    v_cvt_pk_bf16_f32 v99, 0, v99
    v_cvt_pk_bf16_f32 v100, 0, v100
    v_cvt_pk_bf16_f32 v101, 0, v101
    v_cvt_pk_bf16_f32 v102, 0, v102
    v_cvt_pk_bf16_f32 v103, 0, v103
    s_waitcnt lgkmcnt(8)
    s_cmp_lg_u64 s[90:91], 0
    s_cbranch_scc1 Lslow_4
Lback_4:
    v_mul_f32_e32 v96, v80, v96
    v_mul_f32_e32 v97, v81, v97
    v_mul_f32_e32 v98, v82, v98
    v_mul_f32_e32 v99, v83, v99
    v_mul_f32_e32 v100, v84, v100
    v_mul_f32_e32 v101, v85, v101
    v_mul_f32_e32 v102, v86, v102
    v_mul_f32_e32 v103, v87, v103
    v_cvt_pk_bf16_f32 v80, v96, v97
    v_cvt_pk_bf16_f32 v81, v98, v99
    v_cvt_pk_bf16_f32 v82, v100, v101
    v_cvt_pk_bf16_f32 v83, v102, v103
    buffer_store_dwordx4 v[80:83], v4, s[28:31], s12 offen offset:2048 sc1
    v_cvt_pk_bf16_f32 v12, v112, v113
    v_cvt_pk_bf16_f32 v13, v114, v115
    v_cvt_pk_bf16_f32 v14, v116, v117
    v_cvt_pk_bf16_f32 v15, v118, v119
    v_subrev_u32 v12, s46, v12
    v_subrev_u32 v13, s46, v13
    v_subrev_u32 v14, s46, v14
    v_subrev_u32 v15, s46, v15
    v_or3_b32 v11, v12, v13, v14
    v_or_b32 v11, v11, v15
    v_and_b32 v11, 0x70007000, v11
    v_cmp_ne_u32_e64 s[90:91], 0, v11
    v_and_b32 v7, s98, v12
    v_lshlrev_b32_sdwa v112, 1, v7 dst_sel:DWORD dst_unused:UNUSED_PAD src0_sel:DWORD src1_sel:WORD_0
    v_lshlrev_b32_sdwa v113, 1, v7 dst_sel:DWORD dst_unused:UNUSED_PAD src0_sel:DWORD src1_sel:WORD_1
    v_and_b32 v7, s98, v13
    v_lshlrev_b32_sdwa v114, 1, v7 dst_sel:DWORD dst_unused:UNUSED_PAD src0_sel:DWORD src1_sel:WORD_0
    v_lshlrev_b32_sdwa v115, 1, v7 dst_sel:DWORD dst_unused:UNUSED_PAD src0_sel:DWORD src1_sel:WORD_1
    v_and_b32 v7, s98, v14
    v_lshlrev_b32_sdwa v116, 1, v7 dst_sel:DWORD dst_unused:UNUSED_PAD src0_sel:DWORD src1_sel:WORD_0
    v_lshlrev_b32_sdwa v117, 1, v7 dst_sel:DWORD dst_unused:UNUSED_PAD src0_sel:DWORD src1_sel:WORD_1
    v_and_b32 v7, s98, v15
    v_lshlrev_b32_sdwa v118, 1, v7 dst_sel:DWORD dst_unused:UNUSED_PAD src0_sel:DWORD src1_sel:WORD_0
    v_lshlrev_b32_sdwa v119, 1, v7 dst_sel:DWORD dst_unused:UNUSED_PAD src0_sel:DWORD src1_sel:WORD_1
    ds_read_u16_d16_hi v112, v112
    ds_read_u16_d16_hi v113, v113
    ds_read_u16_d16_hi v114, v114
    ds_read_u16_d16_hi v115, v115
    ds_read_u16_d16_hi v116, v116
    ds_read_u16_d16_hi v117, v117
    ds_read_u16_d16_hi v118, v118
    ds_read_u16_d16_hi v119, v119
    v_cvt_pk_bf16_f32 v104, 0, v104
    v_cvt_pk_bf16_f32 v105, 0, v105
    v_cvt_pk_bf16_f32 v106, 0, v106
    v_cvt_pk_bf16_f32 v107, 0, v107
    v_cvt_pk_bf16_f32 v108, 0, v108
    v_cvt_pk_bf16_f32 v109, 0, v109
    v_cvt_pk_bf16_f32 v110, 0, v110
    v_cvt_pk_bf16_f32 v111, 0, v111
    s_waitcnt lgkmcnt(8)
    s_cmp_lg_u64 s[92:93], 0
    s_cbranch_scc1 Lslow_5
Lback_5:
    v_mul_f32_e32 v104, v88, v104
    v_mul_f32_e32 v105, v89, v105
    v_mul_f32_e32 v106, v90, v106
    v_mul_f32_e32 v107, v91, v107
    v_mul_f32_e32 v108, v92, v108
    v_mul_f32_e32 v109, v93, v109
    v_mul_f32_e32 v110, v94, v110
    v_mul_f32_e32 v111, v95, v111
    v_cvt_pk_bf16_f32 v88, v104, v105
    v_cvt_pk_bf16_f32 v89, v106, v107
    v_cvt_pk_bf16_f32 v90, v108, v109
    v_cvt_pk_bf16_f32 v91, v110, v111
    buffer_store_dwordx4 v[88:91], v4, s[28:31], s12 offen offset:3072 sc1
    v_cvt_pk_bf16_f32 v1, v120, v121
    v_cvt_pk_bf16_f32 v2, v122, v123
    v_cvt_pk_bf16_f32 v3, v124, v125
    v_cvt_pk_bf16_f32 v6, v126, v127
    v_subrev_u32 v1, s46, v1
    v_subrev_u32 v2, s46, v2
    v_subrev_u32 v3, s46, v3
    v_subrev_u32 v6, s46, v6
    v_or3_b32 v11, v1, v2, v3
    v_or_b32 v11, v11, v6
    v_and_b32 v11, 0x70007000, v11
    v_cmp_ne_u32_e64 s[92:93], 0, v11
    v_and_b32 v7, s98, v1
    v_lshlrev_b32_sdwa v120, 1, v7 dst_sel:DWORD dst_unused:UNUSED_PAD src0_sel:DWORD src1_sel:WORD_0
    v_lshlrev_b32_sdwa v121, 1, v7 dst_sel:DWORD dst_unused:UNUSED_PAD src0_sel:DWORD src1_sel:WORD_1
    v_and_b32 v7, s98, v2
    v_lshlrev_b32_sdwa v122, 1, v7 dst_sel:DWORD dst_unused:UNUSED_PAD src0_sel:DWORD src1_sel:WORD_0
    v_lshlrev_b32_sdwa v123, 1, v7 dst_sel:DWORD dst_unused:UNUSED_PAD src0_sel:DWORD src1_sel:WORD_1
    v_and_b32 v7, s98, v3
    v_lshlrev_b32_sdwa v124, 1, v7 dst_sel:DWORD dst_unused:UNUSED_PAD src0_sel:DWORD src1_sel:WORD_0
    v_lshlrev_b32_sdwa v125, 1, v7 dst_sel:DWORD dst_unused:UNUSED_PAD src0_sel:DWORD src1_sel:WORD_1
    v_and_b32 v7, s98, v6
    v_lshlrev_b32_sdwa v126, 1, v7 dst_sel:DWORD dst_unused:UNUSED_PAD src0_sel:DWORD src1_sel:WORD_0
    v_lshlrev_b32_sdwa v127, 1, v7 dst_sel:DWORD dst_unused:UNUSED_PAD src0_sel:DWORD src1_sel:WORD_1
    ds_read_u16_d16_hi v120, v120
    ds_read_u16_d16_hi v121, v121
    ds_read_u16_d16_hi v122, v122
    ds_read_u16_d16_hi v123, v123
    ds_read_u16_d16_hi v124, v124
    ds_read_u16_d16_hi v125, v125
    ds_read_u16_d16_hi v126, v126
    ds_read_u16_d16_hi v127, v127
    v_cvt_pk_bf16_f32 v128, 0, v128
    v_cvt_pk_bf16_f32 v129, 0, v129
    v_cvt_pk_bf16_f32 v130, 0, v130
    v_cvt_pk_bf16_f32 v131, 0, v131
    v_cvt_pk_bf16_f32 v132, 0, v132
    v_cvt_pk_bf16_f32 v133, 0, v133
    v_cvt_pk_bf16_f32 v134, 0, v134
    v_cvt_pk_bf16_f32 v135, 0, v135
    s_waitcnt lgkmcnt(8)
    s_cmp_lg_u64 s[90:91], 0
    s_cbranch_scc1 Lslow_6
Lback_6:
    v_mul_f32_e32 v128, v112, v128
    v_mul_f32_e32 v129, v113, v129
    v_mul_f32_e32 v130, v114, v130
    v_mul_f32_e32 v131, v115, v131
    v_mul_f32_e32 v132, v116, v132
    v_mul_f32_e32 v133, v117, v133
    v_mul_f32_e32 v134, v118, v134
    v_mul_f32_e32 v135, v119, v135
    v_cvt_pk_bf16_f32 v112, v128, v129
    v_cvt_pk_bf16_f32 v113, v130, v131
    v_cvt_pk_bf16_f32 v114, v132, v133
    v_cvt_pk_bf16_f32 v115, v134, v135
    buffer_store_dwordx4 v[112:115], v4, s[28:31], s13 offen offset:2048 sc1
    v_cvt_pk_bf16_f32 v136, 0, v136
    v_cvt_pk_bf16_f32 v137, 0, v137
    v_cvt_pk_bf16_f32 v138, 0, v138
    v_cvt_pk_bf16_f32 v139, 0, v139
    v_cvt_pk_bf16_f32 v140, 0, v140
    v_cvt_pk_bf16_f32 v141, 0, v141
    v_cvt_pk_bf16_f32 v142, 0, v142
    v_cvt_pk_bf16_f32 v143, 0, v143
    s_waitcnt lgkmcnt(0)
    s_cmp_lg_u64 s[92:93], 0
    s_cbranch_scc1 Lslow_7
Lback_7:
    v_mul_f32_e32 v136, v120, v136
    v_mul_f32_e32 v137, v121, v137
    v_mul_f32_e32 v138, v122, v138
    v_mul_f32_e32 v139, v123, v139
    v_mul_f32_e32 v140, v124, v140
    v_mul_f32_e32 v141, v125, v141
    v_mul_f32_e32 v142, v126, v142
    v_mul_f32_e32 v143, v127, v143
    v_cvt_pk_bf16_f32 v120, v136, v137
    v_cvt_pk_bf16_f32 v121, v138, v139
    v_cvt_pk_bf16_f32 v122, v140, v141
    v_cvt_pk_bf16_f32 v123, v142, v143
    buffer_store_dwordx4 v[120:123], v4, s[28:31], s13 offen offset:3072 sc1
    s_waitcnt vmcnt(24)
    v_mov_b32 v8, 0
    v_mov_b32 v9, 1
    s_mov_b64 exec, 1
    buffer_atomic_add v9, v8, s[32:35], s60 offen offset:0
    s_mov_b64 exec, -1

    s_waitcnt vmcnt(1)
    v_mov_b32 v8, 0
    v_mov_b32 v9, 1
    s_mov_b64 exec, 1
    buffer_atomic_add v9, v8, s[32:35], s60 offen offset:128
    s_mov_b64 exec, -1

L1_g2:
    s_setprio 0
    v_mov_b32 v6, 0
    s_barrier
    s_mov_b32 s9, 0
Lp_h:
    buffer_load_dword v7, v6, s[32:35], s43 offen offset:0 sc1
    s_waitcnt vmcnt(0)
    v_readfirstlane_b32 s14, v7
    s_add_u32 s9, s9, 1
    s_cmp_ge_u32 s14, 7
    s_cbranch_scc1 Lpd_h
    s_cmp_ge_u32 s9, 60000
    s_cbranch_scc1 Lpd_h
    s_sleep 2
    s_branch Lp_h
Lpd_h:

    s_add_u32 s41, s18, 0
    buffer_load_dwordx4 v[96:99], v4, s[28:31], s41 offen
    buffer_load_dwordx4 v[100:103], v5, s[28:31], s41 offen
    s_add_u32 s41, s18, 1024
    buffer_load_dwordx4 v[104:107], v4, s[28:31], s41 offen
    buffer_load_dwordx4 v[108:111], v5, s[28:31], s41 offen
    s_add_u32 s41, s18, 4096
    buffer_load_dwordx4 v[112:115], v4, s[28:31], s41 offen
    buffer_load_dwordx4 v[116:119], v5, s[28:31], s41 offen
    s_add_u32 s41, s18, 5120
    buffer_load_dwordx4 v[120:123], v4, s[28:31], s41 offen
    buffer_load_dwordx4 v[124:127], v5, s[28:31], s41 offen
    s_add_u32 s41, s18, 8192
    buffer_load_dwordx4 v[128:131], v4, s[28:31], s41 offen
    buffer_load_dwordx4 v[132:135], v5, s[28:31], s41 offen
    s_add_u32 s41, s18, 9216
    buffer_load_dwordx4 v[136:139], v4, s[28:31], s41 offen
    buffer_load_dwordx4 v[140:143], v5, s[28:31], s41 offen
    s_add_u32 s41, s18, 12288
    buffer_load_dwordx4 v[144:147], v4, s[28:31], s41 offen
    buffer_load_dwordx4 v[148:151], v5, s[28:31], s41 offen
    s_add_u32 s41, s18, 13312
    buffer_load_dwordx4 v[152:155], v4, s[28:31], s41 offen
    buffer_load_dwordx4 v[156:159], v5, s[28:31], s41 offen
    buffer_load_dword v7, v6, s[32:35], s43 offen offset:128 sc1
    v_and_b32 v8, 15, v0
    v_lshrrev_b32 v9, 4, v0
    s_lshl_b32 s62, s44, 6
    s_lshl_b32 s63, s45, 6
    s_lshl_b32 s14, s3, 4
    v_add_u32 v10, s14, v8
    v_add_u32 v11, s62, v10
    v_lshlrev_b32 v13, 10, v11
    v_lshl_add_u32 v13, v9, 4, v13
    s_lshl_b32 s15, s63, 1
    v_add_u32 v13, s15, v13
    v_lshrrev_b32 v12, 3, v0
    v_add_u32 v12, s14, v12
    v_add_u32 v12, s63, v12
    v_lshlrev_b32 v12, 12, v12
    v_and_b32 v11, 7, v0
    v_lshl_add_u32 v12, v11, 4, v12
    s_lshl_b32 s15, s62, 1
    v_add_u32 v12, s15, v12
    s_lshl_b32 s20, s3, 11
    s_add_u32 s20, s20, 65536
    s_mov_b32 s21, 32768
    s_lshl_b32 s14, s44, 3
    s_add_u32 s45, s45, s14
    s_add_u32 s45, s45, 128
    s_lshl_b32 s45, s45, 8
    v_and_b32 v11, 31, v0
    v_lshrrev_b32 v14, 5, v0
    v_xor_b32 v14, v14, v8
    v_lshlrev_b32 v14, 4, v14
    v_lshl_add_u32 v14, v11, 8, v14
    s_lshl_b32 s14, s3, 14
    v_add_u32 v14, s14, v14
    v_lshlrev_b32 v15, 1, v9
    v_xor_b32 v15, v15, v8
    v_lshlrev_b32 v15, 4, v15
    v_lshl_add_u32 v15, v10, 8, v15
    v_lshrrev_b32 v1, 2, v8
    v_lshl_add_u32 v1, v9, 3, v1
    v_lshlrev_b32 v1, 7, v1
    v_and_b32 v11, 3, v0
    v_lshl_add_u32 v1, v11, 3, v1
    s_lshl_b32 s14, s3, 5
    s_add_u32 s14, s14, 65536
    v_add_u32 v1, s14, v1
    v_add_u32 v2, s61, v4
    v_add_u32 v3, s8, v4

    s_lshl_b32 s45, s63, 2
    s_add_u32 s45, s45, 65536
    v_lshlrev_b32 v9, 2, v0
    buffer_load_dword v10, v9, s[32:35], s45 offen sc1

    s_waitcnt vmcnt(16)
    v_mfma_f32_32x32x16_bf16 v[16:31], v[248:251], v[96:99], 0
    v_mfma_f32_32x32x16_bf16 v[48:63], v[252:255], v[96:99], 0
    v_mfma_f32_32x32x16_bf16 v[32:47], v[248:251], v[100:103], 0
    v_mfma_f32_32x32x16_bf16 v[64:79], v[252:255], v[100:103], 0
    s_add_u32 s41, s18, 16384
    buffer_load_dwordx4 v[96:99], v4, s[28:31], s41 offen
    buffer_load_dwordx4 v[100:103], v5, s[28:31], s41 offen
    s_waitcnt vmcnt(16)
    v_mfma_f32_32x32x16_bf16 v[16:31], v[168:171], v[104:107], v[16:31]
    v_mfma_f32_32x32x16_bf16 v[48:63], v[172:175], v[104:107], v[48:63]
    v_mfma_f32_32x32x16_bf16 v[32:47], v[168:171], v[108:111], v[32:47]
    v_mfma_f32_32x32x16_bf16 v[64:79], v[172:175], v[108:111], v[64:79]
    s_add_u32 s41, s18, 17408
    buffer_load_dwordx4 v[104:107], v4, s[28:31], s41 offen
    buffer_load_dwordx4 v[108:111], v5, s[28:31], s41 offen
    s_add_u32 s41, s18, 20480
    buffer_load_dwordx4 v[168:171], v4, s[28:31], s41 offen
    buffer_load_dwordx4 v[172:175], v5, s[28:31], s41 offen
    s_waitcnt vmcnt(18)
    v_mfma_f32_32x32x16_bf16 v[16:31], v[176:179], v[112:115], v[16:31]
    v_mfma_f32_32x32x16_bf16 v[48:63], v[180:183], v[112:115], v[48:63]
    v_mfma_f32_32x32x16_bf16 v[32:47], v[176:179], v[116:119], v[32:47]
    v_mfma_f32_32x32x16_bf16 v[64:79], v[180:183], v[116:119], v[64:79]
    s_add_u32 s41, s18, 21504
    buffer_load_dwordx4 v[112:115], v4, s[28:31], s41 offen
    buffer_load_dwordx4 v[116:119], v5, s[28:31], s41 offen
    s_add_u32 s41, s18, 24576
    buffer_load_dwordx4 v[176:179], v4, s[28:31], s41 offen
    buffer_load_dwordx4 v[180:183], v5, s[28:31], s41 offen
    s_waitcnt vmcnt(20)
    v_mfma_f32_32x32x16_bf16 v[16:31], v[184:187], v[120:123], v[16:31]
    v_mfma_f32_32x32x16_bf16 v[48:63], v[188:191], v[120:123], v[48:63]
    v_mfma_f32_32x32x16_bf16 v[32:47], v[184:187], v[124:127], v[32:47]
    v_mfma_f32_32x32x16_bf16 v[64:79], v[188:191], v[124:127], v[64:79]
    s_add_u32 s41, s18, 25600
    buffer_load_dwordx4 v[120:123], v4, s[28:31], s41 offen
    buffer_load_dwordx4 v[124:127], v5, s[28:31], s41 offen
    s_waitcnt vmcnt(13)
    v_readfirstlane_b32 s14, v7
    s_cmp_ge_u32 s14, 7
    s_cbranch_scc1 Lpd_hb

    s_mov_b32 s9, 0
Lp_hb:
    buffer_load_dword v7, v6, s[32:35], s43 offen offset:128 sc1
    s_waitcnt vmcnt(0)
    v_readfirstlane_b32 s14, v7
    s_add_u32 s9, s9, 1
    s_cmp_ge_u32 s14, 7
    s_cbranch_scc1 Lpd_hb
    s_cmp_ge_u32 s9, 60000
    s_cbranch_scc1 Lpd_hb
    s_sleep 2
    s_branch Lp_hb
Lpd_hb:

    s_add_u32 s41, s18, 2048
    buffer_load_dwordx4 v[184:187], v4, s[28:31], s41 offen
    buffer_load_dwordx4 v[188:191], v5, s[28:31], s41 offen
    s_waitcnt vmcnt(22)
    v_mfma_f32_32x32x16_bf16 v[16:31], v[192:195], v[128:131], v[16:31]
    v_mfma_f32_32x32x16_bf16 v[48:63], v[196:199], v[128:131], v[48:63]
    v_mfma_f32_32x32x16_bf16 v[32:47], v[192:195], v[132:135], v[32:47]
    v_mfma_f32_32x32x16_bf16 v[64:79], v[196:199], v[132:135], v[64:79]
    s_add_u32 s41, s18, 3072
    buffer_load_dwordx4 v[128:131], v4, s[28:31], s41 offen
    buffer_load_dwordx4 v[132:135], v5, s[28:31], s41 offen
    s_add_u32 s41, s18, 6144
    buffer_load_dwordx4 v[192:195], v4, s[28:31], s41 offen
    buffer_load_dwordx4 v[196:199], v5, s[28:31], s41 offen
    s_waitcnt vmcnt(24)
    v_mfma_f32_32x32x16_bf16 v[16:31], v[200:203], v[136:139], v[16:31]
    v_mfma_f32_32x32x16_bf16 v[48:63], v[204:207], v[136:139], v[48:63]
    v_mfma_f32_32x32x16_bf16 v[32:47], v[200:203], v[140:143], v[32:47]
    v_mfma_f32_32x32x16_bf16 v[64:79], v[204:207], v[140:143], v[64:79]
    s_add_u32 s41, s18, 7168
    buffer_load_dwordx4 v[136:139], v4, s[28:31], s41 offen
    buffer_load_dwordx4 v[140:143], v5, s[28:31], s41 offen
    s_add_u32 s41, s18, 10240
    buffer_load_dwordx4 v[200:203], v4, s[28:31], s41 offen
    buffer_load_dwordx4 v[204:207], v5, s[28:31], s41 offen
    s_waitcnt vmcnt(26)
    v_mfma_f32_32x32x16_bf16 v[16:31], v[208:211], v[144:147], v[16:31]
    v_mfma_f32_32x32x16_bf16 v[48:63], v[212:215], v[144:147], v[48:63]
    v_mfma_f32_32x32x16_bf16 v[32:47], v[208:211], v[148:151], v[32:47]
    v_mfma_f32_32x32x16_bf16 v[64:79], v[212:215], v[148:151], v[64:79]
    s_add_u32 s41, s18, 11264
    buffer_load_dwordx4 v[144:147], v4, s[28:31], s41 offen
    buffer_load_dwordx4 v[148:151], v5, s[28:31], s41 offen
    s_add_u32 s41, s18, 14336
    buffer_load_dwordx4 v[208:211], v4, s[28:31], s41 offen
    buffer_load_dwordx4 v[212:215], v5, s[28:31], s41 offen
    s_waitcnt vmcnt(28)
    v_mfma_f32_32x32x16_bf16 v[16:31], v[216:219], v[152:155], v[16:31]
    v_mfma_f32_32x32x16_bf16 v[48:63], v[220:223], v[152:155], v[48:63]
    v_mfma_f32_32x32x16_bf16 v[32:47], v[216:219], v[156:159], v[32:47]
    v_mfma_f32_32x32x16_bf16 v[64:79], v[220:223], v[156:159], v[64:79]
    s_add_u32 s41, s19, 14336
    buffer_load_dwordx4 v[152:155], v4, s[84:87], s41 offen
    buffer_load_dwordx4 v[156:159], v5, s[84:87], s41 offen
    s_add_u32 s41, s18, 15360
    buffer_load_dwordx4 v[216:219], v4, s[28:31], s41 offen
    buffer_load_dwordx4 v[220:223], v5, s[28:31], s41 offen
    s_waitcnt vmcnt(28)
    v_mfma_f32_32x32x16_bf16 v[16:31], v[224:227], v[96:99], v[16:31]
    v_mfma_f32_32x32x16_bf16 v[48:63], v[228:231], v[96:99], v[48:63]
    v_mfma_f32_32x32x16_bf16 v[32:47], v[224:227], v[100:103], v[32:47]
    v_mfma_f32_32x32x16_bf16 v[64:79], v[228:231], v[100:103], v[64:79]
    s_add_u32 s41, s19, 15360
    buffer_load_dwordx4 v[96:99], v4, s[84:87], s41 offen
    buffer_load_dwordx4 v[100:103], v5, s[84:87], s41 offen
    s_add_u32 s41, s18, 18432
    buffer_load_dwordx4 v[224:227], v4, s[28:31], s41 offen
    buffer_load_dwordx4 v[228:231], v5, s[28:31], s41 offen
    s_waitcnt vmcnt(30)
    v_mfma_f32_32x32x16_bf16 v[16:31], v[232:235], v[104:107], v[16:31]
    v_mfma_f32_32x32x16_bf16 v[48:63], v[236:239], v[104:107], v[48:63]
    v_mfma_f32_32x32x16_bf16 v[32:47], v[232:235], v[108:111], v[32:47]
    v_mfma_f32_32x32x16_bf16 v[64:79], v[236:239], v[108:111], v[64:79]
    s_add_u32 s41, s19, 18432
    buffer_load_dwordx4 v[104:107], v4, s[84:87], s41 offen
    buffer_load_dwordx4 v[108:111], v5, s[84:87], s41 offen
    s_add_u32 s41, s18, 19456
    buffer_load_dwordx4 v[232:235], v4, s[28:31], s41 offen
    buffer_load_dwordx4 v[236:239], v5, s[28:31], s41 offen
    s_waitcnt vmcnt(32)
    v_mfma_f32_32x32x16_bf16 v[16:31], v[240:243], v[168:171], v[16:31]
    v_mfma_f32_32x32x16_bf16 v[48:63], v[244:247], v[168:171], v[48:63]
    v_mfma_f32_32x32x16_bf16 v[32:47], v[240:243], v[172:175], v[32:47]
    v_mfma_f32_32x32x16_bf16 v[64:79], v[244:247], v[172:175], v[64:79]
    s_add_u32 s41, s19, 19456
    buffer_load_dwordx4 v[168:171], v4, s[84:87], s41 offen
    buffer_load_dwordx4 v[172:175], v5, s[84:87], s41 offen
    s_add_u32 s41, s18, 22528
    buffer_load_dwordx4 v[240:243], v4, s[28:31], s41 offen
    buffer_load_dwordx4 v[244:247], v5, s[28:31], s41 offen
    ds_read_b128 v[80:83], v2 offset:0
    ds_read_b128 v[84:87], v2 offset:1024
    s_waitcnt vmcnt(34)
    v_mfma_f32_32x32x16_bf16 v[16:31], v[160:163], v[112:115], v[16:31]
    v_mfma_f32_32x32x16_bf16 v[48:63], v[164:167], v[112:115], v[48:63]
    v_mfma_f32_32x32x16_bf16 v[32:47], v[160:163], v[116:119], v[32:47]
    v_mfma_f32_32x32x16_bf16 v[64:79], v[164:167], v[116:119], v[64:79]
    s_add_u32 s41, s19, 22528
    buffer_load_dwordx4 v[112:115], v4, s[84:87], s41 offen
    buffer_load_dwordx4 v[116:119], v5, s[84:87], s41 offen
    s_add_u32 s41, s18, 23552
    buffer_load_dwordx4 v[160:163], v4, s[28:31], s41 offen
    buffer_load_dwordx4 v[164:167], v5, s[28:31], s41 offen
    ds_read_b128 v[88:91], v2 offset:2048
    ds_read_b128 v[92:95], v2 offset:3072
    s_waitcnt vmcnt(36)
    s_waitcnt lgkmcnt(2)
    v_mfma_f32_32x32x16_bf16 v[16:31], v[80:83], v[176:179], v[16:31]
    v_mfma_f32_32x32x16_bf16 v[48:63], v[84:87], v[176:179], v[48:63]
    v_mfma_f32_32x32x16_bf16 v[32:47], v[80:83], v[180:183], v[32:47]
    v_mfma_f32_32x32x16_bf16 v[64:79], v[84:87], v[180:183], v[64:79]
    s_add_u32 s41, s19, 23552
    buffer_load_dwordx4 v[176:179], v4, s[84:87], s41 offen
    buffer_load_dwordx4 v[180:183], v5, s[84:87], s41 offen
    ds_read_b128 v[80:83], v2 offset:4096
    ds_read_b128 v[84:87], v2 offset:5120
    s_waitcnt vmcnt(36)
    s_waitcnt lgkmcnt(2)
    v_mfma_f32_32x32x16_bf16 v[16:31], v[88:91], v[120:123], v[16:31]
    v_mfma_f32_32x32x16_bf16 v[48:63], v[92:95], v[120:123], v[48:63]
    v_mfma_f32_32x32x16_bf16 v[32:47], v[88:91], v[124:127], v[32:47]
    v_mfma_f32_32x32x16_bf16 v[64:79], v[92:95], v[124:127], v[64:79]
    s_add_u32 s41, s18, 26624
    buffer_load_dwordx4 v[120:123], v4, s[28:31], s41 offen
    buffer_load_dwordx4 v[124:127], v5, s[28:31], s41 offen
    ds_read_b128 v[88:91], v2 offset:6144
    ds_read_b128 v[92:95], v2 offset:7168
    s_waitcnt vmcnt(36)
    s_waitcnt lgkmcnt(2)
    v_mfma_f32_32x32x16_bf16 v[16:31], v[80:83], v[184:187], v[16:31]
    v_mfma_f32_32x32x16_bf16 v[48:63], v[84:87], v[184:187], v[48:63]
    v_mfma_f32_32x32x16_bf16 v[32:47], v[80:83], v[188:191], v[32:47]
    v_mfma_f32_32x32x16_bf16 v[64:79], v[84:87], v[188:191], v[64:79]
    s_add_u32 s41, s19, 26624
    buffer_load_dwordx4 v[184:187], v4, s[84:87], s41 offen
    buffer_load_dwordx4 v[188:191], v5, s[84:87], s41 offen
    ds_read_b128 v[80:83], v3 offset:0
    ds_read_b128 v[84:87], v3 offset:1024
    s_waitcnt vmcnt(36)
    s_waitcnt lgkmcnt(2)
    v_mfma_f32_32x32x16_bf16 v[16:31], v[88:91], v[128:131], v[16:31]
    v_mfma_f32_32x32x16_bf16 v[48:63], v[92:95], v[128:131], v[48:63]
    v_mfma_f32_32x32x16_bf16 v[32:47], v[88:91], v[132:135], v[32:47]
    v_mfma_f32_32x32x16_bf16 v[64:79], v[92:95], v[132:135], v[64:79]
    s_add_u32 s41, s18, 27648
    buffer_load_dwordx4 v[128:131], v4, s[28:31], s41 offen
    buffer_load_dwordx4 v[132:135], v5, s[28:31], s41 offen
    ds_read_b128 v[88:91], v3 offset:2048
    ds_read_b128 v[92:95], v3 offset:3072
    s_waitcnt vmcnt(36)
    s_waitcnt lgkmcnt(2)
    v_mfma_f32_32x32x16_bf16 v[16:31], v[80:83], v[192:195], v[16:31]
    v_mfma_f32_32x32x16_bf16 v[48:63], v[84:87], v[192:195], v[48:63]
    v_mfma_f32_32x32x16_bf16 v[32:47], v[80:83], v[196:199], v[32:47]
    v_mfma_f32_32x32x16_bf16 v[64:79], v[84:87], v[196:199], v[64:79]
    s_add_u32 s41, s19, 27648
    buffer_load_dwordx4 v[192:195], v4, s[84:87], s41 offen
    buffer_load_dwordx4 v[196:199], v5, s[84:87], s41 offen
    ds_read_b128 v[80:83], v3 offset:4096
    ds_read_b128 v[84:87], v3 offset:5120
    s_waitcnt vmcnt(36)
    s_waitcnt lgkmcnt(2)
    v_mfma_f32_32x32x16_bf16 v[16:31], v[88:91], v[136:139], v[16:31]
    v_mfma_f32_32x32x16_bf16 v[48:63], v[92:95], v[136:139], v[48:63]
    v_mfma_f32_32x32x16_bf16 v[32:47], v[88:91], v[140:143], v[32:47]
    v_mfma_f32_32x32x16_bf16 v[64:79], v[92:95], v[140:143], v[64:79]
    ds_read_b128 v[88:91], v3 offset:6144
    ds_read_b128 v[92:95], v3 offset:7168
    s_waitcnt vmcnt(34)
    s_waitcnt lgkmcnt(2)
    v_mfma_f32_32x32x16_bf16 v[16:31], v[80:83], v[200:203], v[16:31]
    v_mfma_f32_32x32x16_bf16 v[48:63], v[84:87], v[200:203], v[48:63]
    v_mfma_f32_32x32x16_bf16 v[32:47], v[80:83], v[204:207], v[32:47]
    v_mfma_f32_32x32x16_bf16 v[64:79], v[84:87], v[204:207], v[64:79]
    buffer_load_dwordx4 v[248:251], v13, s[48:51], 0 offen offset:0
    buffer_load_dwordx4 v[252:255], v13, s[48:51], 0 offen offset:64
    s_waitcnt vmcnt(58)
    s_mov_b32 s9, 0
Lp_af:
    v_cmp_ne_u32 vcc, 0, v10
    s_nop 1
    s_cmp_eq_u32 vcc_lo, -1
    s_cbranch_scc1 Lpd_af
    s_add_u32 s9, s9, 1
    s_cmp_ge_u32 s9, 60000
    s_cbranch_scc1 Lpd_af
    s_sleep 4
    buffer_load_dword v10, v9, s[32:35], s45 offen sc1
    s_waitcnt vmcnt(0)
    s_branch Lp_af
Lpd_af:

    buffer_load_dwordx4 v[136:139], v12, s[36:39], 0 offen sc1
    buffer_load_dwordx4 v[140:143], v12, s[36:39], s21 offen sc1
    s_waitcnt vmcnt(36)
    s_waitcnt lgkmcnt(0)
    v_mfma_f32_32x32x16_bf16 v[16:31], v[88:91], v[144:147], v[16:31]
    v_mfma_f32_32x32x16_bf16 v[48:63], v[92:95], v[144:147], v[48:63]
    v_mfma_f32_32x32x16_bf16 v[32:47], v[88:91], v[148:151], v[32:47]
    v_mfma_f32_32x32x16_bf16 v[64:79], v[92:95], v[148:151], v[64:79]
    s_waitcnt vmcnt(32)
    v_mfma_f32_32x32x16_bf16 v[16:31], v[152:155], v[208:211], v[16:31]
    v_mfma_f32_32x32x16_bf16 v[48:63], v[156:159], v[208:211], v[48:63]
    v_mfma_f32_32x32x16_bf16 v[32:47], v[152:155], v[212:215], v[32:47]
    v_mfma_f32_32x32x16_bf16 v[64:79], v[156:159], v[212:215], v[64:79]
    s_waitcnt vmcnt(28)
    v_mfma_f32_32x32x16_bf16 v[16:31], v[96:99], v[216:219], v[16:31]
    v_mfma_f32_32x32x16_bf16 v[48:63], v[100:103], v[216:219], v[48:63]
    v_mfma_f32_32x32x16_bf16 v[32:47], v[96:99], v[220:223], v[32:47]
    v_mfma_f32_32x32x16_bf16 v[64:79], v[100:103], v[220:223], v[64:79]
    s_waitcnt vmcnt(24)
    v_mfma_f32_32x32x16_bf16 v[16:31], v[104:107], v[224:227], v[16:31]
    v_mfma_f32_32x32x16_bf16 v[48:63], v[108:111], v[224:227], v[48:63]
    v_mfma_f32_32x32x16_bf16 v[32:47], v[104:107], v[228:231], v[32:47]
    v_mfma_f32_32x32x16_bf16 v[64:79], v[108:111], v[228:231], v[64:79]
    s_waitcnt vmcnt(20)
    v_mfma_f32_32x32x16_bf16 v[16:31], v[168:171], v[232:235], v[16:31]
    v_mfma_f32_32x32x16_bf16 v[48:63], v[172:175], v[232:235], v[48:63]
    v_mfma_f32_32x32x16_bf16 v[32:47], v[168:171], v[236:239], v[32:47]
    v_mfma_f32_32x32x16_bf16 v[64:79], v[172:175], v[236:239], v[64:79]
    s_waitcnt vmcnt(16)
    v_mfma_f32_32x32x16_bf16 v[16:31], v[112:115], v[240:243], v[16:31]
    v_mfma_f32_32x32x16_bf16 v[48:63], v[116:119], v[240:243], v[48:63]
    v_mfma_f32_32x32x16_bf16 v[32:47], v[112:115], v[244:247], v[32:47]
    v_mfma_f32_32x32x16_bf16 v[64:79], v[116:119], v[244:247], v[64:79]
    s_waitcnt vmcnt(12)
    v_mfma_f32_32x32x16_bf16 v[16:31], v[176:179], v[160:163], v[16:31]
    v_mfma_f32_32x32x16_bf16 v[48:63], v[180:183], v[160:163], v[48:63]
    v_mfma_f32_32x32x16_bf16 v[32:47], v[176:179], v[164:167], v[32:47]
    v_mfma_f32_32x32x16_bf16 v[64:79], v[180:183], v[164:167], v[64:79]
    s_waitcnt vmcnt(0)
    v_max3_u32 v11, v136, v137, v138
    v_max3_u32 v7, v139, v140, v141
    v_max3_u32 v11, v11, v142, v143
    v_max_u32 v11, v11, v7
    v_cmp_eq_u32 vcc, -1, v11
    s_nop 1
    s_cmp_eq_u64 vcc, 0

    s_cselect_b32 s22, 0, 1
    s_waitcnt vmcnt(8)
    v_mfma_f32_32x32x16_bf16 v[16:31], v[184:187], v[120:123], v[16:31]
    v_mfma_f32_32x32x16_bf16 v[48:63], v[188:191], v[120:123], v[48:63]
    v_mfma_f32_32x32x16_bf16 v[32:47], v[184:187], v[124:127], v[32:47]
    v_mfma_f32_32x32x16_bf16 v[64:79], v[188:191], v[124:127], v[64:79]
    s_waitcnt vmcnt(4)
    v_mfma_f32_32x32x16_bf16 v[16:31], v[192:195], v[128:131], v[16:31]
    v_mfma_f32_32x32x16_bf16 v[48:63], v[196:199], v[128:131], v[48:63]
    v_mfma_f32_32x32x16_bf16 v[32:47], v[192:195], v[132:135], v[32:47]
    v_mfma_f32_32x32x16_bf16 v[64:79], v[196:199], v[132:135], v[64:79]
    s_nop 15
    ds_write_b128 v14, v[16:19] offset:0
    v_xor_b32 v11, 32, v14
    ds_write_b128 v11, v[20:23] offset:0
    v_xor_b32 v11, 64, v14
    ds_write_b128 v11, v[24:27] offset:0
    v_xor_b32 v11, 96, v14
    ds_write_b128 v11, v[28:31] offset:0
    ds_write_b128 v14, v[32:35] offset:8192
    v_xor_b32 v11, 32, v14
    ds_write_b128 v11, v[36:39] offset:8192
    v_xor_b32 v11, 64, v14
    ds_write_b128 v11, v[40:43] offset:8192
    v_xor_b32 v11, 96, v14
    ds_write_b128 v11, v[44:47] offset:8192
    v_xor_b32 v11, 128, v14
    ds_write_b128 v11, v[48:51] offset:0
    v_xor_b32 v11, 160, v14
    ds_write_b128 v11, v[52:55] offset:0
    v_xor_b32 v11, 192, v14
    ds_write_b128 v11, v[56:59] offset:0
    v_xor_b32 v11, 224, v14
    ds_write_b128 v11, v[60:63] offset:0
    v_xor_b32 v11, 128, v14
    ds_write_b128 v11, v[64:67] offset:8192
    v_xor_b32 v11, 160, v14
    ds_write_b128 v11, v[68:71] offset:8192
    v_xor_b32 v11, 192, v14
    ds_write_b128 v11, v[72:75] offset:8192
    v_xor_b32 v11, 224, v14
    ds_write_b128 v11, v[76:79] offset:8192
    s_cmp_eq_u32 s22, 0
    s_cbranch_scc1 La_ok
    s_mov_b32 s9, 0
Lp_a:

    buffer_load_dwordx4 v[136:139], v12, s[36:39], 0 offen sc1
    buffer_load_dwordx4 v[140:143], v12, s[36:39], s21 offen sc1
    s_waitcnt vmcnt(0)
    v_max3_u32 v11, v136, v137, v138
    v_max3_u32 v7, v139, v140, v141
    v_max3_u32 v11, v11, v142, v143
    v_max_u32 v11, v11, v7
    v_cmp_eq_u32 vcc, -1, v11
    s_nop 1
    s_cmp_eq_u64 vcc, 0

    s_cbranch_scc1 La_ok
    s_add_u32 s9, s9, 1
    s_cmp_ge_u32 s9, 60000
    s_cbranch_scc1 La_ok
    s_sleep 1
    s_branch Lp_a

La_ok:
    v_add_u32 v11, s20, v4
    ds_write_b128 v11, v[136:139] offset:0
    ds_write_b128 v11, v[140:143] offset:1024
    v_xor_b32 v11, 16, v15
    v_xor_b32 v10, 128, v15
    v_xor_b32 v9, 144, v15
    s_waitcnt vmcnt(0) lgkmcnt(0)
    s_barrier

    ds_read_b128 v[16:19], v15 offset:0
    ds_read_b128 v[20:23], v11 offset:0
    ds_read_b128 v[24:27], v15 offset:16384
    ds_read_b128 v[28:31], v11 offset:16384
    ds_read_b128 v[32:35], v15 offset:32768
    ds_read_b128 v[36:39], v11 offset:32768
    ds_read_b128 v[40:43], v15 offset:49152
    ds_read_b128 v[44:47], v11 offset:49152
    ds_read_b64_tr_b16 v[80:81], v1 offset:0
    ds_read_b64_tr_b16 v[82:83], v1 offset:512
    ds_read_b128 v[48:51], v10 offset:0
    ds_read_b128 v[52:55], v9 offset:0
    ds_read_b128 v[56:59], v10 offset:16384
    ds_read_b128 v[60:63], v9 offset:16384
    ds_read_b128 v[64:67], v10 offset:32768
    ds_read_b128 v[68:71], v9 offset:32768
    ds_read_b128 v[72:75], v10 offset:49152
    ds_read_b128 v[76:79], v9 offset:49152
    ds_read_b64_tr_b16 v[84:85], v1 offset:4096
    ds_read_b64_tr_b16 v[86:87], v1 offset:4608
    s_waitcnt lgkmcnt(10)
    v_add_f32 v16, v16, v24
    v_add_f32 v32, v32, v40
    v_add_f32 v17, v17, v25
    v_add_f32 v33, v33, v41
    v_add_f32 v18, v18, v26
    v_add_f32 v34, v34, v42
    v_add_f32 v19, v19, v27
    v_add_f32 v35, v35, v43
    v_add_f32 v20, v20, v28
    v_add_f32 v36, v36, v44
    v_add_f32 v21, v21, v29
    v_add_f32 v37, v37, v45
    v_add_f32 v22, v22, v30
    v_add_f32 v38, v38, v46
    v_add_f32 v23, v23, v31
    v_add_f32 v39, v39, v47
    v_lshlrev_b32 v24, 16, v80
    v_and_b32 v25, 0xffff0000, v80
    v_lshlrev_b32 v40, 16, v248
    v_and_b32 v41, 0xffff0000, v248

    v_lshlrev_b32 v26, 16, v81
    v_and_b32 v27, 0xffff0000, v81
    v_lshlrev_b32 v42, 16, v249
    v_and_b32 v43, 0xffff0000, v249

    v_lshlrev_b32 v28, 16, v82
    v_and_b32 v29, 0xffff0000, v82
    v_lshlrev_b32 v44, 16, v250
    v_and_b32 v45, 0xffff0000, v250

    v_lshlrev_b32 v30, 16, v83
    v_and_b32 v31, 0xffff0000, v83
    v_lshlrev_b32 v46, 16, v251
    v_and_b32 v47, 0xffff0000, v251

    v_add_f32 v16, v16, v32
    v_add_f32 v24, v24, v40
    v_add_f32 v17, v17, v33
    v_add_f32 v25, v25, v41
    v_add_f32 v18, v18, v34
    v_add_f32 v26, v26, v42
    v_add_f32 v19, v19, v35
    v_add_f32 v27, v27, v43
    v_add_f32 v20, v20, v36
    v_add_f32 v28, v28, v44
    v_add_f32 v21, v21, v37
    v_add_f32 v29, v29, v45
    v_add_f32 v22, v22, v38
    v_add_f32 v30, v30, v46
    v_add_f32 v23, v23, v39
    v_add_f32 v31, v31, v47
    v_cvt_pk_bf16_f32 v16, 0, v16
    v_cvt_pk_bf16_f32 v24, 0, v24
    v_cvt_pk_bf16_f32 v17, 0, v17
    v_cvt_pk_bf16_f32 v25, 0, v25
    v_cvt_pk_bf16_f32 v18, 0, v18
    v_cvt_pk_bf16_f32 v26, 0, v26
    v_cvt_pk_bf16_f32 v19, 0, v19
    v_cvt_pk_bf16_f32 v27, 0, v27
    v_cvt_pk_bf16_f32 v20, 0, v20
    v_cvt_pk_bf16_f32 v28, 0, v28
    v_cvt_pk_bf16_f32 v21, 0, v21
    v_cvt_pk_bf16_f32 v29, 0, v29
    v_cvt_pk_bf16_f32 v22, 0, v22
    v_cvt_pk_bf16_f32 v30, 0, v30
    v_cvt_pk_bf16_f32 v23, 0, v23
    v_cvt_pk_bf16_f32 v31, 0, v31
    v_add_f32 v16, v16, v24
    v_add_f32 v17, v17, v25
    v_add_f32 v18, v18, v26
    v_add_f32 v19, v19, v27
    v_add_f32 v20, v20, v28
    v_add_f32 v21, v21, v29
    v_add_f32 v22, v22, v30
    v_add_f32 v23, v23, v31
    v_cvt_pk_bf16_f32 v32, v16, v17
    v_cvt_pk_bf16_f32 v33, v18, v19
    v_cvt_pk_bf16_f32 v34, v20, v21
    v_cvt_pk_bf16_f32 v35, v22, v23
    buffer_store_dwordx4 v[32:35], v13, s[52:55], 0 offen offset:0
    s_waitcnt lgkmcnt(0)
    v_add_f32 v48, v48, v56
    v_add_f32 v64, v64, v72
    v_add_f32 v49, v49, v57
    v_add_f32 v65, v65, v73
    v_add_f32 v50, v50, v58
    v_add_f32 v66, v66, v74
    v_add_f32 v51, v51, v59
    v_add_f32 v67, v67, v75
    v_add_f32 v52, v52, v60
    v_add_f32 v68, v68, v76
    v_add_f32 v53, v53, v61
    v_add_f32 v69, v69, v77
    v_add_f32 v54, v54, v62
    v_add_f32 v70, v70, v78
    v_add_f32 v55, v55, v63
    v_add_f32 v71, v71, v79
    v_lshlrev_b32 v56, 16, v84
    v_and_b32 v57, 0xffff0000, v84
    v_lshlrev_b32 v72, 16, v252
    v_and_b32 v73, 0xffff0000, v252

    v_lshlrev_b32 v58, 16, v85
    v_and_b32 v59, 0xffff0000, v85
    v_lshlrev_b32 v74, 16, v253
    v_and_b32 v75, 0xffff0000, v253

    v_lshlrev_b32 v60, 16, v86
    v_and_b32 v61, 0xffff0000, v86
    v_lshlrev_b32 v76, 16, v254
    v_and_b32 v77, 0xffff0000, v254

    v_lshlrev_b32 v62, 16, v87
    v_and_b32 v63, 0xffff0000, v87
    v_lshlrev_b32 v78, 16, v255
    v_and_b32 v79, 0xffff0000, v255

    v_add_f32 v48, v48, v64
    v_add_f32 v56, v56, v72
    v_add_f32 v49, v49, v65
    v_add_f32 v57, v57, v73
    v_add_f32 v50, v50, v66
    v_add_f32 v58, v58, v74
    v_add_f32 v51, v51, v67
    v_add_f32 v59, v59, v75
    v_add_f32 v52, v52, v68
    v_add_f32 v60, v60, v76
    v_add_f32 v53, v53, v69
    v_add_f32 v61, v61, v77
    v_add_f32 v54, v54, v70
    v_add_f32 v62, v62, v78
    v_add_f32 v55, v55, v71
    v_add_f32 v63, v63, v79
    v_cvt_pk_bf16_f32 v48, 0, v48
    v_cvt_pk_bf16_f32 v56, 0, v56
    v_cvt_pk_bf16_f32 v49, 0, v49
    v_cvt_pk_bf16_f32 v57, 0, v57
    v_cvt_pk_bf16_f32 v50, 0, v50
    v_cvt_pk_bf16_f32 v58, 0, v58
    v_cvt_pk_bf16_f32 v51, 0, v51
    v_cvt_pk_bf16_f32 v59, 0, v59
    v_cvt_pk_bf16_f32 v52, 0, v52
    v_cvt_pk_bf16_f32 v60, 0, v60
    v_cvt_pk_bf16_f32 v53, 0, v53
    v_cvt_pk_bf16_f32 v61, 0, v61
    v_cvt_pk_bf16_f32 v54, 0, v54
    v_cvt_pk_bf16_f32 v62, 0, v62
    v_cvt_pk_bf16_f32 v55, 0, v55
    v_cvt_pk_bf16_f32 v63, 0, v63
    v_add_f32 v48, v48, v56
    v_add_f32 v49, v49, v57
    v_add_f32 v50, v50, v58
    v_add_f32 v51, v51, v59
    v_add_f32 v52, v52, v60
    v_add_f32 v53, v53, v61
    v_add_f32 v54, v54, v62
    v_add_f32 v55, v55, v63
    v_cvt_pk_bf16_f32 v64, v48, v49
    v_cvt_pk_bf16_f32 v65, v50, v51
    v_cvt_pk_bf16_f32 v66, v52, v53
    v_cvt_pk_bf16_f32 v67, v54, v55
    buffer_store_dwordx4 v[64:67], v13, s[52:55], 0 offen offset:64
    s_endpgm
Lslow_0:
    s_waitcnt lgkmcnt(0)
    v_add_u32 v12, s46, v12
    v_lshlrev_b32 v7, 16, v12
    v_and_b32 v12, 0xffff0000, v12

    v_mul_f32_e32 v16, v7, v7
    v_fma_f32 v16, v16, s47, v10
    v_mul_f32_e32 v16, v16, v7
    v_exp_f32_e32 v16, v16
    s_nop 0
    v_add_f32_e32 v16, 1.0, v16
    v_rcp_f32_e32 v16, v16
    s_nop 0
    v_mul_f32_e32 v16, v16, v7
    v_cvt_pk_bf16_f32 v16, 0, v16

    v_mul_f32_e32 v17, v12, v12
    v_fma_f32 v17, v17, s47, v10
    v_mul_f32_e32 v17, v17, v12
    v_exp_f32_e32 v17, v17
    s_nop 0
    v_add_f32_e32 v17, 1.0, v17
    v_rcp_f32_e32 v17, v17
    s_nop 0
    v_mul_f32_e32 v17, v17, v12
    v_cvt_pk_bf16_f32 v17, 0, v17

    v_add_u32 v13, s46, v13
    v_lshlrev_b32 v7, 16, v13
    v_and_b32 v13, 0xffff0000, v13

    v_mul_f32_e32 v18, v7, v7
    v_fma_f32 v18, v18, s47, v10
    v_mul_f32_e32 v18, v18, v7
    v_exp_f32_e32 v18, v18
    s_nop 0
    v_add_f32_e32 v18, 1.0, v18
    v_rcp_f32_e32 v18, v18
    s_nop 0
    v_mul_f32_e32 v18, v18, v7
    v_cvt_pk_bf16_f32 v18, 0, v18

    v_mul_f32_e32 v19, v13, v13
    v_fma_f32 v19, v19, s47, v10
    v_mul_f32_e32 v19, v19, v13
    v_exp_f32_e32 v19, v19
    s_nop 0
    v_add_f32_e32 v19, 1.0, v19
    v_rcp_f32_e32 v19, v19
    s_nop 0
    v_mul_f32_e32 v19, v19, v13
    v_cvt_pk_bf16_f32 v19, 0, v19

    v_add_u32 v14, s46, v14
    v_lshlrev_b32 v7, 16, v14
    v_and_b32 v14, 0xffff0000, v14

    v_mul_f32_e32 v20, v7, v7
    v_fma_f32 v20, v20, s47, v10
    v_mul_f32_e32 v20, v20, v7
    v_exp_f32_e32 v20, v20
    s_nop 0
    v_add_f32_e32 v20, 1.0, v20
    v_rcp_f32_e32 v20, v20
    s_nop 0
    v_mul_f32_e32 v20, v20, v7
    v_cvt_pk_bf16_f32 v20, 0, v20

    v_mul_f32_e32 v21, v14, v14
    v_fma_f32 v21, v21, s47, v10
    v_mul_f32_e32 v21, v21, v14
    v_exp_f32_e32 v21, v21
    s_nop 0
    v_add_f32_e32 v21, 1.0, v21
    v_rcp_f32_e32 v21, v21
    s_nop 0
    v_mul_f32_e32 v21, v21, v14
    v_cvt_pk_bf16_f32 v21, 0, v21

    v_add_u32 v15, s46, v15
    v_lshlrev_b32 v7, 16, v15
    v_and_b32 v15, 0xffff0000, v15

    v_mul_f32_e32 v22, v7, v7
    v_fma_f32 v22, v22, s47, v10
    v_mul_f32_e32 v22, v22, v7
    v_exp_f32_e32 v22, v22
    s_nop 0
    v_add_f32_e32 v22, 1.0, v22
    v_rcp_f32_e32 v22, v22
    s_nop 0
    v_mul_f32_e32 v22, v22, v7
    v_cvt_pk_bf16_f32 v22, 0, v22

    v_mul_f32_e32 v23, v15, v15
    v_fma_f32 v23, v23, s47, v10
    v_mul_f32_e32 v23, v23, v15
    v_exp_f32_e32 v23, v23
    s_nop 0
    v_add_f32_e32 v23, 1.0, v23
    v_rcp_f32_e32 v23, v23
    s_nop 0
    v_mul_f32_e32 v23, v23, v15
    v_cvt_pk_bf16_f32 v23, 0, v23

    s_branch Lback_0
Lslow_1:
    s_waitcnt lgkmcnt(0)
    v_add_u32 v1, s46, v1
    v_lshlrev_b32 v7, 16, v1
    v_and_b32 v1, 0xffff0000, v1

    v_mul_f32_e32 v24, v7, v7
    v_fma_f32 v24, v24, s47, v10
    v_mul_f32_e32 v24, v24, v7
    v_exp_f32_e32 v24, v24
    s_nop 0
    v_add_f32_e32 v24, 1.0, v24
    v_rcp_f32_e32 v24, v24
    s_nop 0
    v_mul_f32_e32 v24, v24, v7
    v_cvt_pk_bf16_f32 v24, 0, v24

    v_mul_f32_e32 v25, v1, v1
    v_fma_f32 v25, v25, s47, v10
    v_mul_f32_e32 v25, v25, v1
    v_exp_f32_e32 v25, v25
    s_nop 0
    v_add_f32_e32 v25, 1.0, v25
    v_rcp_f32_e32 v25, v25
    s_nop 0
    v_mul_f32_e32 v25, v25, v1
    v_cvt_pk_bf16_f32 v25, 0, v25

    v_add_u32 v2, s46, v2
    v_lshlrev_b32 v7, 16, v2
    v_and_b32 v2, 0xffff0000, v2

    v_mul_f32_e32 v26, v7, v7
    v_fma_f32 v26, v26, s47, v10
    v_mul_f32_e32 v26, v26, v7
    v_exp_f32_e32 v26, v26
    s_nop 0
    v_add_f32_e32 v26, 1.0, v26
    v_rcp_f32_e32 v26, v26
    s_nop 0
    v_mul_f32_e32 v26, v26, v7
    v_cvt_pk_bf16_f32 v26, 0, v26

    v_mul_f32_e32 v27, v2, v2
    v_fma_f32 v27, v27, s47, v10
    v_mul_f32_e32 v27, v27, v2
    v_exp_f32_e32 v27, v27
    s_nop 0
    v_add_f32_e32 v27, 1.0, v27
    v_rcp_f32_e32 v27, v27
    s_nop 0
    v_mul_f32_e32 v27, v27, v2
    v_cvt_pk_bf16_f32 v27, 0, v27

    v_add_u32 v3, s46, v3
    v_lshlrev_b32 v7, 16, v3
    v_and_b32 v3, 0xffff0000, v3

    v_mul_f32_e32 v28, v7, v7
    v_fma_f32 v28, v28, s47, v10
    v_mul_f32_e32 v28, v28, v7
    v_exp_f32_e32 v28, v28
    s_nop 0
    v_add_f32_e32 v28, 1.0, v28
    v_rcp_f32_e32 v28, v28
    s_nop 0
    v_mul_f32_e32 v28, v28, v7
    v_cvt_pk_bf16_f32 v28, 0, v28

    v_mul_f32_e32 v29, v3, v3
    v_fma_f32 v29, v29, s47, v10
    v_mul_f32_e32 v29, v29, v3
    v_exp_f32_e32 v29, v29
    s_nop 0
    v_add_f32_e32 v29, 1.0, v29
    v_rcp_f32_e32 v29, v29
    s_nop 0
    v_mul_f32_e32 v29, v29, v3
    v_cvt_pk_bf16_f32 v29, 0, v29

    v_add_u32 v6, s46, v6
    v_lshlrev_b32 v7, 16, v6
    v_and_b32 v6, 0xffff0000, v6

    v_mul_f32_e32 v30, v7, v7
    v_fma_f32 v30, v30, s47, v10
    v_mul_f32_e32 v30, v30, v7
    v_exp_f32_e32 v30, v30
    s_nop 0
    v_add_f32_e32 v30, 1.0, v30
    v_rcp_f32_e32 v30, v30
    s_nop 0
    v_mul_f32_e32 v30, v30, v7
    v_cvt_pk_bf16_f32 v30, 0, v30

    v_mul_f32_e32 v31, v6, v6
    v_fma_f32 v31, v31, s47, v10
    v_mul_f32_e32 v31, v31, v6
    v_exp_f32_e32 v31, v31
    s_nop 0
    v_add_f32_e32 v31, 1.0, v31
    v_rcp_f32_e32 v31, v31
    s_nop 0
    v_mul_f32_e32 v31, v31, v6
    v_cvt_pk_bf16_f32 v31, 0, v31

    s_branch Lback_1
Lslow_2:
    s_waitcnt lgkmcnt(0)
    v_add_u32 v12, s46, v12
    v_lshlrev_b32 v7, 16, v12
    v_and_b32 v12, 0xffff0000, v12

    v_mul_f32_e32 v48, v7, v7
    v_fma_f32 v48, v48, s47, v10
    v_mul_f32_e32 v48, v48, v7
    v_exp_f32_e32 v48, v48
    s_nop 0
    v_add_f32_e32 v48, 1.0, v48
    v_rcp_f32_e32 v48, v48
    s_nop 0
    v_mul_f32_e32 v48, v48, v7
    v_cvt_pk_bf16_f32 v48, 0, v48

    v_mul_f32_e32 v49, v12, v12
    v_fma_f32 v49, v49, s47, v10
    v_mul_f32_e32 v49, v49, v12
    v_exp_f32_e32 v49, v49
    s_nop 0
    v_add_f32_e32 v49, 1.0, v49
    v_rcp_f32_e32 v49, v49
    s_nop 0
    v_mul_f32_e32 v49, v49, v12
    v_cvt_pk_bf16_f32 v49, 0, v49

    v_add_u32 v13, s46, v13
    v_lshlrev_b32 v7, 16, v13
    v_and_b32 v13, 0xffff0000, v13

    v_mul_f32_e32 v50, v7, v7
    v_fma_f32 v50, v50, s47, v10
    v_mul_f32_e32 v50, v50, v7
    v_exp_f32_e32 v50, v50
    s_nop 0
    v_add_f32_e32 v50, 1.0, v50
    v_rcp_f32_e32 v50, v50
    s_nop 0
    v_mul_f32_e32 v50, v50, v7
    v_cvt_pk_bf16_f32 v50, 0, v50

    v_mul_f32_e32 v51, v13, v13
    v_fma_f32 v51, v51, s47, v10
    v_mul_f32_e32 v51, v51, v13
    v_exp_f32_e32 v51, v51
    s_nop 0
    v_add_f32_e32 v51, 1.0, v51
    v_rcp_f32_e32 v51, v51
    s_nop 0
    v_mul_f32_e32 v51, v51, v13
    v_cvt_pk_bf16_f32 v51, 0, v51

    v_add_u32 v14, s46, v14
    v_lshlrev_b32 v7, 16, v14
    v_and_b32 v14, 0xffff0000, v14

    v_mul_f32_e32 v52, v7, v7
    v_fma_f32 v52, v52, s47, v10
    v_mul_f32_e32 v52, v52, v7
    v_exp_f32_e32 v52, v52
    s_nop 0
    v_add_f32_e32 v52, 1.0, v52
    v_rcp_f32_e32 v52, v52
    s_nop 0
    v_mul_f32_e32 v52, v52, v7
    v_cvt_pk_bf16_f32 v52, 0, v52

    v_mul_f32_e32 v53, v14, v14
    v_fma_f32 v53, v53, s47, v10
    v_mul_f32_e32 v53, v53, v14
    v_exp_f32_e32 v53, v53
    s_nop 0
    v_add_f32_e32 v53, 1.0, v53
    v_rcp_f32_e32 v53, v53
    s_nop 0
    v_mul_f32_e32 v53, v53, v14
    v_cvt_pk_bf16_f32 v53, 0, v53

    v_add_u32 v15, s46, v15
    v_lshlrev_b32 v7, 16, v15
    v_and_b32 v15, 0xffff0000, v15

    v_mul_f32_e32 v54, v7, v7
    v_fma_f32 v54, v54, s47, v10
    v_mul_f32_e32 v54, v54, v7
    v_exp_f32_e32 v54, v54
    s_nop 0
    v_add_f32_e32 v54, 1.0, v54
    v_rcp_f32_e32 v54, v54
    s_nop 0
    v_mul_f32_e32 v54, v54, v7
    v_cvt_pk_bf16_f32 v54, 0, v54

    v_mul_f32_e32 v55, v15, v15
    v_fma_f32 v55, v55, s47, v10
    v_mul_f32_e32 v55, v55, v15
    v_exp_f32_e32 v55, v55
    s_nop 0
    v_add_f32_e32 v55, 1.0, v55
    v_rcp_f32_e32 v55, v55
    s_nop 0
    v_mul_f32_e32 v55, v55, v15
    v_cvt_pk_bf16_f32 v55, 0, v55

    s_branch Lback_2
Lslow_3:
    s_waitcnt lgkmcnt(0)
    v_add_u32 v1, s46, v1
    v_lshlrev_b32 v7, 16, v1
    v_and_b32 v1, 0xffff0000, v1

    v_mul_f32_e32 v56, v7, v7
    v_fma_f32 v56, v56, s47, v10
    v_mul_f32_e32 v56, v56, v7
    v_exp_f32_e32 v56, v56
    s_nop 0
    v_add_f32_e32 v56, 1.0, v56
    v_rcp_f32_e32 v56, v56
    s_nop 0
    v_mul_f32_e32 v56, v56, v7
    v_cvt_pk_bf16_f32 v56, 0, v56

    v_mul_f32_e32 v57, v1, v1
    v_fma_f32 v57, v57, s47, v10
    v_mul_f32_e32 v57, v57, v1
    v_exp_f32_e32 v57, v57
    s_nop 0
    v_add_f32_e32 v57, 1.0, v57
    v_rcp_f32_e32 v57, v57
    s_nop 0
    v_mul_f32_e32 v57, v57, v1
    v_cvt_pk_bf16_f32 v57, 0, v57

    v_add_u32 v2, s46, v2
    v_lshlrev_b32 v7, 16, v2
    v_and_b32 v2, 0xffff0000, v2

    v_mul_f32_e32 v58, v7, v7
    v_fma_f32 v58, v58, s47, v10
    v_mul_f32_e32 v58, v58, v7
    v_exp_f32_e32 v58, v58
    s_nop 0
    v_add_f32_e32 v58, 1.0, v58
    v_rcp_f32_e32 v58, v58
    s_nop 0
    v_mul_f32_e32 v58, v58, v7
    v_cvt_pk_bf16_f32 v58, 0, v58

    v_mul_f32_e32 v59, v2, v2
    v_fma_f32 v59, v59, s47, v10
    v_mul_f32_e32 v59, v59, v2
    v_exp_f32_e32 v59, v59
    s_nop 0
    v_add_f32_e32 v59, 1.0, v59
    v_rcp_f32_e32 v59, v59
    s_nop 0
    v_mul_f32_e32 v59, v59, v2
    v_cvt_pk_bf16_f32 v59, 0, v59

    v_add_u32 v3, s46, v3
    v_lshlrev_b32 v7, 16, v3
    v_and_b32 v3, 0xffff0000, v3

    v_mul_f32_e32 v60, v7, v7
    v_fma_f32 v60, v60, s47, v10
    v_mul_f32_e32 v60, v60, v7
    v_exp_f32_e32 v60, v60
    s_nop 0
    v_add_f32_e32 v60, 1.0, v60
    v_rcp_f32_e32 v60, v60
    s_nop 0
    v_mul_f32_e32 v60, v60, v7
    v_cvt_pk_bf16_f32 v60, 0, v60

    v_mul_f32_e32 v61, v3, v3
    v_fma_f32 v61, v61, s47, v10
    v_mul_f32_e32 v61, v61, v3
    v_exp_f32_e32 v61, v61
    s_nop 0
    v_add_f32_e32 v61, 1.0, v61
    v_rcp_f32_e32 v61, v61
    s_nop 0
    v_mul_f32_e32 v61, v61, v3
    v_cvt_pk_bf16_f32 v61, 0, v61

    v_add_u32 v6, s46, v6
    v_lshlrev_b32 v7, 16, v6
    v_and_b32 v6, 0xffff0000, v6

    v_mul_f32_e32 v62, v7, v7
    v_fma_f32 v62, v62, s47, v10
    v_mul_f32_e32 v62, v62, v7
    v_exp_f32_e32 v62, v62
    s_nop 0
    v_add_f32_e32 v62, 1.0, v62
    v_rcp_f32_e32 v62, v62
    s_nop 0
    v_mul_f32_e32 v62, v62, v7
    v_cvt_pk_bf16_f32 v62, 0, v62

    v_mul_f32_e32 v63, v6, v6
    v_fma_f32 v63, v63, s47, v10
    v_mul_f32_e32 v63, v63, v6
    v_exp_f32_e32 v63, v63
    s_nop 0
    v_add_f32_e32 v63, 1.0, v63
    v_rcp_f32_e32 v63, v63
    s_nop 0
    v_mul_f32_e32 v63, v63, v6
    v_cvt_pk_bf16_f32 v63, 0, v63

    s_branch Lback_3
Lslow_4:
    s_waitcnt lgkmcnt(0)
    v_add_u32 v12, s46, v12
    v_lshlrev_b32 v7, 16, v12
    v_and_b32 v12, 0xffff0000, v12

    v_mul_f32_e32 v80, v7, v7
    v_fma_f32 v80, v80, s47, v10
    v_mul_f32_e32 v80, v80, v7
    v_exp_f32_e32 v80, v80
    s_nop 0
    v_add_f32_e32 v80, 1.0, v80
    v_rcp_f32_e32 v80, v80
    s_nop 0
    v_mul_f32_e32 v80, v80, v7
    v_cvt_pk_bf16_f32 v80, 0, v80

    v_mul_f32_e32 v81, v12, v12
    v_fma_f32 v81, v81, s47, v10
    v_mul_f32_e32 v81, v81, v12
    v_exp_f32_e32 v81, v81
    s_nop 0
    v_add_f32_e32 v81, 1.0, v81
    v_rcp_f32_e32 v81, v81
    s_nop 0
    v_mul_f32_e32 v81, v81, v12
    v_cvt_pk_bf16_f32 v81, 0, v81

    v_add_u32 v13, s46, v13
    v_lshlrev_b32 v7, 16, v13
    v_and_b32 v13, 0xffff0000, v13

    v_mul_f32_e32 v82, v7, v7
    v_fma_f32 v82, v82, s47, v10
    v_mul_f32_e32 v82, v82, v7
    v_exp_f32_e32 v82, v82
    s_nop 0
    v_add_f32_e32 v82, 1.0, v82
    v_rcp_f32_e32 v82, v82
    s_nop 0
    v_mul_f32_e32 v82, v82, v7
    v_cvt_pk_bf16_f32 v82, 0, v82

    v_mul_f32_e32 v83, v13, v13
    v_fma_f32 v83, v83, s47, v10
    v_mul_f32_e32 v83, v83, v13
    v_exp_f32_e32 v83, v83
    s_nop 0
    v_add_f32_e32 v83, 1.0, v83
    v_rcp_f32_e32 v83, v83
    s_nop 0
    v_mul_f32_e32 v83, v83, v13
    v_cvt_pk_bf16_f32 v83, 0, v83

    v_add_u32 v14, s46, v14
    v_lshlrev_b32 v7, 16, v14
    v_and_b32 v14, 0xffff0000, v14

    v_mul_f32_e32 v84, v7, v7
    v_fma_f32 v84, v84, s47, v10
    v_mul_f32_e32 v84, v84, v7
    v_exp_f32_e32 v84, v84
    s_nop 0
    v_add_f32_e32 v84, 1.0, v84
    v_rcp_f32_e32 v84, v84
    s_nop 0
    v_mul_f32_e32 v84, v84, v7
    v_cvt_pk_bf16_f32 v84, 0, v84

    v_mul_f32_e32 v85, v14, v14
    v_fma_f32 v85, v85, s47, v10
    v_mul_f32_e32 v85, v85, v14
    v_exp_f32_e32 v85, v85
    s_nop 0
    v_add_f32_e32 v85, 1.0, v85
    v_rcp_f32_e32 v85, v85
    s_nop 0
    v_mul_f32_e32 v85, v85, v14
    v_cvt_pk_bf16_f32 v85, 0, v85

    v_add_u32 v15, s46, v15
    v_lshlrev_b32 v7, 16, v15
    v_and_b32 v15, 0xffff0000, v15

    v_mul_f32_e32 v86, v7, v7
    v_fma_f32 v86, v86, s47, v10
    v_mul_f32_e32 v86, v86, v7
    v_exp_f32_e32 v86, v86
    s_nop 0
    v_add_f32_e32 v86, 1.0, v86
    v_rcp_f32_e32 v86, v86
    s_nop 0
    v_mul_f32_e32 v86, v86, v7
    v_cvt_pk_bf16_f32 v86, 0, v86

    v_mul_f32_e32 v87, v15, v15
    v_fma_f32 v87, v87, s47, v10
    v_mul_f32_e32 v87, v87, v15
    v_exp_f32_e32 v87, v87
    s_nop 0
    v_add_f32_e32 v87, 1.0, v87
    v_rcp_f32_e32 v87, v87
    s_nop 0
    v_mul_f32_e32 v87, v87, v15
    v_cvt_pk_bf16_f32 v87, 0, v87

    s_branch Lback_4
Lslow_5:
    s_waitcnt lgkmcnt(0)
    v_add_u32 v1, s46, v1
    v_lshlrev_b32 v7, 16, v1
    v_and_b32 v1, 0xffff0000, v1

    v_mul_f32_e32 v88, v7, v7
    v_fma_f32 v88, v88, s47, v10
    v_mul_f32_e32 v88, v88, v7
    v_exp_f32_e32 v88, v88
    s_nop 0
    v_add_f32_e32 v88, 1.0, v88
    v_rcp_f32_e32 v88, v88
    s_nop 0
    v_mul_f32_e32 v88, v88, v7
    v_cvt_pk_bf16_f32 v88, 0, v88

    v_mul_f32_e32 v89, v1, v1
    v_fma_f32 v89, v89, s47, v10
    v_mul_f32_e32 v89, v89, v1
    v_exp_f32_e32 v89, v89
    s_nop 0
    v_add_f32_e32 v89, 1.0, v89
    v_rcp_f32_e32 v89, v89
    s_nop 0
    v_mul_f32_e32 v89, v89, v1
    v_cvt_pk_bf16_f32 v89, 0, v89

    v_add_u32 v2, s46, v2
    v_lshlrev_b32 v7, 16, v2
    v_and_b32 v2, 0xffff0000, v2

    v_mul_f32_e32 v90, v7, v7
    v_fma_f32 v90, v90, s47, v10
    v_mul_f32_e32 v90, v90, v7
    v_exp_f32_e32 v90, v90
    s_nop 0
    v_add_f32_e32 v90, 1.0, v90
    v_rcp_f32_e32 v90, v90
    s_nop 0
    v_mul_f32_e32 v90, v90, v7
    v_cvt_pk_bf16_f32 v90, 0, v90

    v_mul_f32_e32 v91, v2, v2
    v_fma_f32 v91, v91, s47, v10
    v_mul_f32_e32 v91, v91, v2
    v_exp_f32_e32 v91, v91
    s_nop 0
    v_add_f32_e32 v91, 1.0, v91
    v_rcp_f32_e32 v91, v91
    s_nop 0
    v_mul_f32_e32 v91, v91, v2
    v_cvt_pk_bf16_f32 v91, 0, v91

    v_add_u32 v3, s46, v3
    v_lshlrev_b32 v7, 16, v3
    v_and_b32 v3, 0xffff0000, v3

    v_mul_f32_e32 v92, v7, v7
    v_fma_f32 v92, v92, s47, v10
    v_mul_f32_e32 v92, v92, v7
    v_exp_f32_e32 v92, v92
    s_nop 0
    v_add_f32_e32 v92, 1.0, v92
    v_rcp_f32_e32 v92, v92
    s_nop 0
    v_mul_f32_e32 v92, v92, v7
    v_cvt_pk_bf16_f32 v92, 0, v92

    v_mul_f32_e32 v93, v3, v3
    v_fma_f32 v93, v93, s47, v10
    v_mul_f32_e32 v93, v93, v3
    v_exp_f32_e32 v93, v93
    s_nop 0
    v_add_f32_e32 v93, 1.0, v93
    v_rcp_f32_e32 v93, v93
    s_nop 0
    v_mul_f32_e32 v93, v93, v3
    v_cvt_pk_bf16_f32 v93, 0, v93

    v_add_u32 v6, s46, v6
    v_lshlrev_b32 v7, 16, v6
    v_and_b32 v6, 0xffff0000, v6

    v_mul_f32_e32 v94, v7, v7
    v_fma_f32 v94, v94, s47, v10
    v_mul_f32_e32 v94, v94, v7
    v_exp_f32_e32 v94, v94
    s_nop 0
    v_add_f32_e32 v94, 1.0, v94
    v_rcp_f32_e32 v94, v94
    s_nop 0
    v_mul_f32_e32 v94, v94, v7
    v_cvt_pk_bf16_f32 v94, 0, v94

    v_mul_f32_e32 v95, v6, v6
    v_fma_f32 v95, v95, s47, v10
    v_mul_f32_e32 v95, v95, v6
    v_exp_f32_e32 v95, v95
    s_nop 0
    v_add_f32_e32 v95, 1.0, v95
    v_rcp_f32_e32 v95, v95
    s_nop 0
    v_mul_f32_e32 v95, v95, v6
    v_cvt_pk_bf16_f32 v95, 0, v95

    s_branch Lback_5
Lslow_6:
    s_waitcnt lgkmcnt(0)
    v_add_u32 v12, s46, v12
    v_lshlrev_b32 v7, 16, v12
    v_and_b32 v12, 0xffff0000, v12

    v_mul_f32_e32 v112, v7, v7
    v_fma_f32 v112, v112, s47, v10
    v_mul_f32_e32 v112, v112, v7
    v_exp_f32_e32 v112, v112
    s_nop 0
    v_add_f32_e32 v112, 1.0, v112
    v_rcp_f32_e32 v112, v112
    s_nop 0
    v_mul_f32_e32 v112, v112, v7
    v_cvt_pk_bf16_f32 v112, 0, v112

    v_mul_f32_e32 v113, v12, v12
    v_fma_f32 v113, v113, s47, v10
    v_mul_f32_e32 v113, v113, v12
    v_exp_f32_e32 v113, v113
    s_nop 0
    v_add_f32_e32 v113, 1.0, v113
    v_rcp_f32_e32 v113, v113
    s_nop 0
    v_mul_f32_e32 v113, v113, v12
    v_cvt_pk_bf16_f32 v113, 0, v113

    v_add_u32 v13, s46, v13
    v_lshlrev_b32 v7, 16, v13
    v_and_b32 v13, 0xffff0000, v13

    v_mul_f32_e32 v114, v7, v7
    v_fma_f32 v114, v114, s47, v10
    v_mul_f32_e32 v114, v114, v7
    v_exp_f32_e32 v114, v114
    s_nop 0
    v_add_f32_e32 v114, 1.0, v114
    v_rcp_f32_e32 v114, v114
    s_nop 0
    v_mul_f32_e32 v114, v114, v7
    v_cvt_pk_bf16_f32 v114, 0, v114

    v_mul_f32_e32 v115, v13, v13
    v_fma_f32 v115, v115, s47, v10
    v_mul_f32_e32 v115, v115, v13
    v_exp_f32_e32 v115, v115
    s_nop 0
    v_add_f32_e32 v115, 1.0, v115
    v_rcp_f32_e32 v115, v115
    s_nop 0
    v_mul_f32_e32 v115, v115, v13
    v_cvt_pk_bf16_f32 v115, 0, v115

    v_add_u32 v14, s46, v14
    v_lshlrev_b32 v7, 16, v14
    v_and_b32 v14, 0xffff0000, v14

    v_mul_f32_e32 v116, v7, v7
    v_fma_f32 v116, v116, s47, v10
    v_mul_f32_e32 v116, v116, v7
    v_exp_f32_e32 v116, v116
    s_nop 0
    v_add_f32_e32 v116, 1.0, v116
    v_rcp_f32_e32 v116, v116
    s_nop 0
    v_mul_f32_e32 v116, v116, v7
    v_cvt_pk_bf16_f32 v116, 0, v116

    v_mul_f32_e32 v117, v14, v14
    v_fma_f32 v117, v117, s47, v10
    v_mul_f32_e32 v117, v117, v14
    v_exp_f32_e32 v117, v117
    s_nop 0
    v_add_f32_e32 v117, 1.0, v117
    v_rcp_f32_e32 v117, v117
    s_nop 0
    v_mul_f32_e32 v117, v117, v14
    v_cvt_pk_bf16_f32 v117, 0, v117

    v_add_u32 v15, s46, v15
    v_lshlrev_b32 v7, 16, v15
    v_and_b32 v15, 0xffff0000, v15

    v_mul_f32_e32 v118, v7, v7
    v_fma_f32 v118, v118, s47, v10
    v_mul_f32_e32 v118, v118, v7
    v_exp_f32_e32 v118, v118
    s_nop 0
    v_add_f32_e32 v118, 1.0, v118
    v_rcp_f32_e32 v118, v118
    s_nop 0
    v_mul_f32_e32 v118, v118, v7
    v_cvt_pk_bf16_f32 v118, 0, v118

    v_mul_f32_e32 v119, v15, v15
    v_fma_f32 v119, v119, s47, v10
    v_mul_f32_e32 v119, v119, v15
    v_exp_f32_e32 v119, v119
    s_nop 0
    v_add_f32_e32 v119, 1.0, v119
    v_rcp_f32_e32 v119, v119
    s_nop 0
    v_mul_f32_e32 v119, v119, v15
    v_cvt_pk_bf16_f32 v119, 0, v119

    s_branch Lback_6
Lslow_7:
    s_waitcnt lgkmcnt(0)
    v_add_u32 v1, s46, v1
    v_lshlrev_b32 v7, 16, v1
    v_and_b32 v1, 0xffff0000, v1

    v_mul_f32_e32 v120, v7, v7
    v_fma_f32 v120, v120, s47, v10
    v_mul_f32_e32 v120, v120, v7
    v_exp_f32_e32 v120, v120
    s_nop 0
    v_add_f32_e32 v120, 1.0, v120
    v_rcp_f32_e32 v120, v120
    s_nop 0
    v_mul_f32_e32 v120, v120, v7
    v_cvt_pk_bf16_f32 v120, 0, v120

    v_mul_f32_e32 v121, v1, v1
    v_fma_f32 v121, v121, s47, v10
    v_mul_f32_e32 v121, v121, v1
    v_exp_f32_e32 v121, v121
    s_nop 0
    v_add_f32_e32 v121, 1.0, v121
    v_rcp_f32_e32 v121, v121
    s_nop 0
    v_mul_f32_e32 v121, v121, v1
    v_cvt_pk_bf16_f32 v121, 0, v121

    v_add_u32 v2, s46, v2
    v_lshlrev_b32 v7, 16, v2
    v_and_b32 v2, 0xffff0000, v2

    v_mul_f32_e32 v122, v7, v7
    v_fma_f32 v122, v122, s47, v10
    v_mul_f32_e32 v122, v122, v7
    v_exp_f32_e32 v122, v122
    s_nop 0
    v_add_f32_e32 v122, 1.0, v122
    v_rcp_f32_e32 v122, v122
    s_nop 0
    v_mul_f32_e32 v122, v122, v7
    v_cvt_pk_bf16_f32 v122, 0, v122

    v_mul_f32_e32 v123, v2, v2
    v_fma_f32 v123, v123, s47, v10
    v_mul_f32_e32 v123, v123, v2
    v_exp_f32_e32 v123, v123
    s_nop 0
    v_add_f32_e32 v123, 1.0, v123
    v_rcp_f32_e32 v123, v123
    s_nop 0
    v_mul_f32_e32 v123, v123, v2
    v_cvt_pk_bf16_f32 v123, 0, v123

    v_add_u32 v3, s46, v3
    v_lshlrev_b32 v7, 16, v3
    v_and_b32 v3, 0xffff0000, v3

    v_mul_f32_e32 v124, v7, v7
    v_fma_f32 v124, v124, s47, v10
    v_mul_f32_e32 v124, v124, v7
    v_exp_f32_e32 v124, v124
    s_nop 0
    v_add_f32_e32 v124, 1.0, v124
    v_rcp_f32_e32 v124, v124
    s_nop 0
    v_mul_f32_e32 v124, v124, v7
    v_cvt_pk_bf16_f32 v124, 0, v124

    v_mul_f32_e32 v125, v3, v3
    v_fma_f32 v125, v125, s47, v10
    v_mul_f32_e32 v125, v125, v3
    v_exp_f32_e32 v125, v125
    s_nop 0
    v_add_f32_e32 v125, 1.0, v125
    v_rcp_f32_e32 v125, v125
    s_nop 0
    v_mul_f32_e32 v125, v125, v3
    v_cvt_pk_bf16_f32 v125, 0, v125

    v_add_u32 v6, s46, v6
    v_lshlrev_b32 v7, 16, v6
    v_and_b32 v6, 0xffff0000, v6

    v_mul_f32_e32 v126, v7, v7
    v_fma_f32 v126, v126, s47, v10
    v_mul_f32_e32 v126, v126, v7
    v_exp_f32_e32 v126, v126
    s_nop 0
    v_add_f32_e32 v126, 1.0, v126
    v_rcp_f32_e32 v126, v126
    s_nop 0
    v_mul_f32_e32 v126, v126, v7
    v_cvt_pk_bf16_f32 v126, 0, v126

    v_mul_f32_e32 v127, v6, v6
    v_fma_f32 v127, v127, s47, v10
    v_mul_f32_e32 v127, v127, v6
    v_exp_f32_e32 v127, v127
    s_nop 0
    v_add_f32_e32 v127, 1.0, v127
    v_rcp_f32_e32 v127, v127
    s_nop 0
    v_mul_f32_e32 v127, v127, v6
    v_cvt_pk_bf16_f32 v127, 0, v127

    s_branch Lback_7
L1_h:
    s_add_u32 s84, s16, 0x1200000
    s_addc_u32 s85, s17, 0
    s_and_b32 s85, s85, 0xffff
    s_mov_b32 s86, 0x218000
    s_mov_b32 s87, 0x20000
    s_and_b32 s44, s2, 7
    s_lshl_b32 s44, s44, 2
    s_bfe_u32 s45, s2, 0x20003
    s_add_u32 s44, s44, s45
    s_lshr_b32 s45, s2, 5
    s_mul_i32 s14, s3, 29696
    s_mul_i32 s18, s44, 239104
    s_add_u32 s18, s18, s14
    s_mul_i32 s19, s45, 239104
    s_add_u32 s19, s19, s14
    s_lshl_b32 s43, s44, 2
    s_add_u32 s43, s43, s3
    s_lshl_b32 s43, s43, 8
    s_lshl_b32 s61, s3, 14
    s_add_u32 s8, s61, 8192
    s_cmp_eq_u32 s3, 0
    s_cselect_b32 s61, 73728, s61
    v_lshlrev_b32 v4, 4, v0
    v_add_u32 v5, 119552, v4
    s_lshr_b32 s4, s2, 3
    s_lshl_b32 s14, s3, 5
    s_add_u32 s4, s4, s14
    s_lshl_b32 s4, s4, 8
    s_add_u32 s4, s4, 2129920

    s_add_u32 s32, s16, 0x1400000
    s_addc_u32 s33, s17, 0
    s_and_b32 s33, s33, 0xffff
    s_mov_b32 s34, 0x18000
    s_mov_b32 s35, 0x20000
    s_add_u32 s36, s16, 0x1000000
    s_addc_u32 s37, s17, 0
    s_and_b32 s37, s37, 0xffff
    s_mov_b32 s38, 0x200000
    s_mov_b32 s39, 0x20000
    s_mov_b32 s48, s56
    s_and_b32 s49, s57, 0xffff
    s_mov_b32 s50, 0x200000
    s_mov_b32 s51, 0x20000
    s_mov_b32 s52, s58
    s_and_b32 s53, s59, 0xffff
    s_mov_b32 s54, 0x200000
    s_mov_b32 s55, 0x20000
    s_setprio 3
    s_sub_u32 s20, s2, 224
    s_cmp_ge_u32 s20, 28
    s_cbranch_scc1 Lh_nosw
    s_load_dwordx2 s[22:23], s[0:1], 80
    s_lshl_b32 s21, s20, 16
    s_lshl_b32 s14, s3, 12
    s_add_u32 s21, s21, s14
    s_mul_i32 s40, s20, 37
    s_lshr_b32 s40, s40, 8
    s_lshl_b32 s41, s20, 2
    s_mul_i32 s42, s40, 1
    s_add_u32 s41, s41, s42
    s_lshl_b32 s41, s41, 10
    s_mul_i32 s42, s3, 478208
    s_add_u32 s41, s41, s42
    v_lshrrev_b32 v1, 5, v0
    v_bfe_u32 v2, v0, 2, 2
    v_lshl_add_u32 v1, v1, 2, v2
    v_lshlrev_b32 v1, 10, v1
    v_bfe_u32 v2, v0, 4, 1
    v_lshl_add_u32 v1, v2, 5, v1
    v_and_b32 v2, 3, v0
    v_lshl_add_u32 v1, v2, 3, v1
    s_lshl_b32 s42, s3, 8
    v_add_u32 v1, s42, v1
    s_waitcnt lgkmcnt(0)

    s_mov_b32 s24, s22
    s_and_b32 s25, s23, 0xffff
    s_mov_b32 s26, 0x1c0000
    s_mov_b32 s27, 0x20000
    s_add_u32 s15, s21, 0
    s_add_u32 m0, s14, 0
    s_nop 0
    buffer_load_dwordx4 v4, s[24:27], s15 offen offset:0 lds
    buffer_load_dwordx4 v4, s[24:27], s15 offen offset:1024 lds
    buffer_load_dwordx4 v4, s[24:27], s15 offen offset:2048 lds
    buffer_load_dwordx4 v4, s[24:27], s15 offen offset:3072 lds
    s_add_u32 s15, s21, 16384
    s_add_u32 m0, s14, 16384
    s_nop 0
    buffer_load_dwordx4 v4, s[24:27], s15 offen offset:0 lds
    buffer_load_dwordx4 v4, s[24:27], s15 offen offset:1024 lds
    buffer_load_dwordx4 v4, s[24:27], s15 offen offset:2048 lds
    buffer_load_dwordx4 v4, s[24:27], s15 offen offset:3072 lds
    s_add_u32 s15, s21, 32768
    s_add_u32 m0, s14, 32768
    s_nop 0
    buffer_load_dwordx4 v4, s[24:27], s15 offen offset:0 lds
    buffer_load_dwordx4 v4, s[24:27], s15 offen offset:1024 lds
    buffer_load_dwordx4 v4, s[24:27], s15 offen offset:2048 lds
    buffer_load_dwordx4 v4, s[24:27], s15 offen offset:3072 lds
    s_add_u32 s15, s21, 49152
    s_add_u32 m0, s14, 49152
    s_nop 0
    buffer_load_dwordx4 v4, s[24:27], s15 offen offset:0 lds
    buffer_load_dwordx4 v4, s[24:27], s15 offen offset:1024 lds
    buffer_load_dwordx4 v4, s[24:27], s15 offen offset:2048 lds
    buffer_load_dwordx4 v4, s[24:27], s15 offen offset:3072 lds
    s_waitcnt vmcnt(12) lgkmcnt(0)
    s_barrier
    ds_read_b64_tr_b16 v[16:17], v1 offset:0
    ds_read_b64_tr_b16 v[18:19], v1 offset:8192
    ds_read_b64_tr_b16 v[20:21], v1 offset:64
    ds_read_b64_tr_b16 v[22:23], v1 offset:8256
    ds_read_b64_tr_b16 v[24:25], v1 offset:128
    ds_read_b64_tr_b16 v[26:27], v1 offset:8320
    ds_read_b64_tr_b16 v[28:29], v1 offset:192
    ds_read_b64_tr_b16 v[30:31], v1 offset:8384
    s_waitcnt vmcnt(8) lgkmcnt(0)
    s_barrier
    ds_read_b64_tr_b16 v[32:33], v1 offset:16384
    ds_read_b64_tr_b16 v[34:35], v1 offset:24576
    ds_read_b64_tr_b16 v[36:37], v1 offset:16448
    ds_read_b64_tr_b16 v[38:39], v1 offset:24640
    ds_read_b64_tr_b16 v[40:41], v1 offset:16512
    ds_read_b64_tr_b16 v[42:43], v1 offset:24704
    ds_read_b64_tr_b16 v[44:45], v1 offset:16576
    ds_read_b64_tr_b16 v[46:47], v1 offset:24768
    s_waitcnt vmcnt(4) lgkmcnt(0)
    s_barrier
    ds_read_b64_tr_b16 v[48:49], v1 offset:32768
    ds_read_b64_tr_b16 v[50:51], v1 offset:40960
    ds_read_b64_tr_b16 v[52:53], v1 offset:32832
    ds_read_b64_tr_b16 v[54:55], v1 offset:41024
    ds_read_b64_tr_b16 v[56:57], v1 offset:32896
    ds_read_b64_tr_b16 v[58:59], v1 offset:41088
    ds_read_b64_tr_b16 v[60:61], v1 offset:32960
    ds_read_b64_tr_b16 v[62:63], v1 offset:41152
    s_waitcnt vmcnt(0) lgkmcnt(0)
    s_barrier
    ds_read_b64_tr_b16 v[64:65], v1 offset:49152
    ds_read_b64_tr_b16 v[66:67], v1 offset:57344
    ds_read_b64_tr_b16 v[68:69], v1 offset:49216
    ds_read_b64_tr_b16 v[70:71], v1 offset:57408
    ds_read_b64_tr_b16 v[72:73], v1 offset:49280
    ds_read_b64_tr_b16 v[74:75], v1 offset:57472
    ds_read_b64_tr_b16 v[76:77], v1 offset:49344
    ds_read_b64_tr_b16 v[78:79], v1 offset:57536
    s_add_u32 s15, s41, 0
    buffer_store_dwordx4 v[16:19], v4, s[84:87], s15 offen sc1
    s_add_u32 s15, s41, 119552
    buffer_store_dwordx4 v[20:23], v4, s[84:87], s15 offen sc1
    s_add_u32 s15, s41, 239104
    buffer_store_dwordx4 v[24:27], v4, s[84:87], s15 offen sc1
    s_add_u32 s15, s41, 358656
    buffer_store_dwordx4 v[28:31], v4, s[84:87], s15 offen sc1
    s_add_u32 s15, s41, 1024
    buffer_store_dwordx4 v[32:35], v4, s[84:87], s15 offen sc1
    s_add_u32 s15, s41, 120576
    buffer_store_dwordx4 v[36:39], v4, s[84:87], s15 offen sc1
    s_add_u32 s15, s41, 240128
    buffer_store_dwordx4 v[40:43], v4, s[84:87], s15 offen sc1
    s_add_u32 s15, s41, 359680
    buffer_store_dwordx4 v[44:47], v4, s[84:87], s15 offen sc1
    s_add_u32 s15, s41, 2048
    buffer_store_dwordx4 v[48:51], v4, s[84:87], s15 offen sc1
    s_add_u32 s15, s41, 121600
    buffer_store_dwordx4 v[52:55], v4, s[84:87], s15 offen sc1
    s_add_u32 s15, s41, 241152
    buffer_store_dwordx4 v[56:59], v4, s[84:87], s15 offen sc1
    s_add_u32 s15, s41, 360704
    buffer_store_dwordx4 v[60:63], v4, s[84:87], s15 offen sc1
    s_waitcnt lgkmcnt(6)
    s_add_u32 s15, s41, 3072
    buffer_store_dwordx4 v[64:67], v4, s[84:87], s15 offen sc1
    s_waitcnt lgkmcnt(4)
    s_add_u32 s15, s41, 122624
    buffer_store_dwordx4 v[68:71], v4, s[84:87], s15 offen sc1
    s_waitcnt lgkmcnt(2)
    s_add_u32 s15, s41, 242176
    buffer_store_dwordx4 v[72:75], v4, s[84:87], s15 offen sc1
    s_waitcnt lgkmcnt(0)
    s_add_u32 s15, s41, 361728
    buffer_store_dwordx4 v[76:79], v4, s[84:87], s15 offen sc1
    s_mul_i32 s42, s40, 7
    s_sub_u32 s42, s20, s42
    s_lshl_b32 s42, s42, 2
    s_add_u32 s42, s42, s3
    s_lshl_b32 s42, s42, 2
    s_lshl_b32 s40, s40, 13
    s_add_u32 s40, s40, 2129920
    s_add_u32 s40, s40, s42
    v_lshlrev_b32 v8, 8, v0
    v_mov_b32 v9, 1
    s_waitcnt vmcnt(0)
    s_mov_b32 exec_hi, 0
    buffer_store_dword v9, v8, s[84:87], s40 offen sc1
    s_mov_b64 exec, -1
    s_barrier

Lh_nosw:
    s_setprio 0
    v_lshlrev_b32 v3, 2, v0
    s_mov_b32 s9, 0
Lp_wfh:
    buffer_load_dword v7, v3, s[84:87], s4 offen sc1
    s_waitcnt vmcnt(0)
    v_cmp_ne_u32_e64 s[14:15], 0, v7
    s_nop 1
    s_cmp_eq_u32 s14, 0x0fffffff
    s_cbranch_scc1 Lpd_wfh
    s_add_u32 s9, s9, 1
    s_cmp_ge_u32 s9, 60000
    s_cbranch_scc1 Lpd_wfh
    s_sleep 4
    s_branch Lp_wfh
Lpd_wfh:

    s_add_u32 s14, s19, 0
    buffer_load_dwordx4 v[248:251], v4, s[84:87], s14 offen
    buffer_load_dwordx4 v[252:255], v5, s[84:87], s14 offen
    s_add_u32 s14, s19, 1024
    buffer_load_dwordx4 v[168:171], v4, s[84:87], s14 offen
    buffer_load_dwordx4 v[172:175], v5, s[84:87], s14 offen
    s_add_u32 s14, s19, 4096
    buffer_load_dwordx4 v[176:179], v4, s[84:87], s14 offen
    buffer_load_dwordx4 v[180:183], v5, s[84:87], s14 offen
    s_add_u32 s14, s19, 5120
    buffer_load_dwordx4 v[184:187], v4, s[84:87], s14 offen
    buffer_load_dwordx4 v[188:191], v5, s[84:87], s14 offen
    s_add_u32 s14, s19, 8192
    buffer_load_dwordx4 v[192:195], v4, s[84:87], s14 offen
    buffer_load_dwordx4 v[196:199], v5, s[84:87], s14 offen
    s_add_u32 s14, s19, 9216
    buffer_load_dwordx4 v[200:203], v4, s[84:87], s14 offen
    buffer_load_dwordx4 v[204:207], v5, s[84:87], s14 offen
    s_add_u32 s14, s19, 12288
    buffer_load_dwordx4 v[208:211], v4, s[84:87], s14 offen
    buffer_load_dwordx4 v[212:215], v5, s[84:87], s14 offen
    s_add_u32 s14, s19, 13312
    buffer_load_dwordx4 v[216:219], v4, s[84:87], s14 offen
    buffer_load_dwordx4 v[220:223], v5, s[84:87], s14 offen
    s_add_u32 s14, s19, 16384
    buffer_load_dwordx4 v[224:227], v4, s[84:87], s14 offen
    buffer_load_dwordx4 v[228:231], v5, s[84:87], s14 offen
    s_add_u32 s14, s19, 17408
    buffer_load_dwordx4 v[232:235], v4, s[84:87], s14 offen
    buffer_load_dwordx4 v[236:239], v5, s[84:87], s14 offen
    s_add_u32 s14, s19, 20480
    buffer_load_dwordx4 v[240:243], v4, s[84:87], s14 offen
    buffer_load_dwordx4 v[244:247], v5, s[84:87], s14 offen
    s_add_u32 s14, s19, 21504
    buffer_load_dwordx4 v[160:163], v4, s[84:87], s14 offen
    buffer_load_dwordx4 v[164:167], v5, s[84:87], s14 offen
    s_add_u32 s14, s19, 24576
    s_add_u32 m0, s61, 0
    s_nop 0
    buffer_load_dwordx4 v4, s[84:87], s14 offen lds
    s_add_u32 m0, s61, 1024
    s_nop 0
    buffer_load_dwordx4 v5, s[84:87], s14 offen lds
    s_add_u32 s14, s19, 25600
    s_add_u32 m0, s61, 2048
    s_nop 0
    buffer_load_dwordx4 v4, s[84:87], s14 offen lds
    s_add_u32 m0, s61, 3072
    s_nop 0
    buffer_load_dwordx4 v5, s[84:87], s14 offen lds
    s_add_u32 s14, s19, 2048
    s_add_u32 m0, s61, 4096
    s_nop 0
    buffer_load_dwordx4 v4, s[84:87], s14 offen lds
    s_add_u32 m0, s61, 5120
    s_nop 0
    buffer_load_dwordx4 v5, s[84:87], s14 offen lds
    s_add_u32 s14, s19, 3072
    s_add_u32 m0, s61, 6144
    s_nop 0
    buffer_load_dwordx4 v4, s[84:87], s14 offen lds
    s_add_u32 m0, s61, 7168
    s_nop 0
    buffer_load_dwordx4 v5, s[84:87], s14 offen lds
    s_add_u32 s14, s19, 6144
    s_add_u32 m0, s8, 0
    s_nop 0
    buffer_load_dwordx4 v4, s[84:87], s14 offen lds
    s_add_u32 m0, s8, 1024
    s_nop 0
    buffer_load_dwordx4 v5, s[84:87], s14 offen lds
    s_add_u32 s14, s19, 7168
    s_add_u32 m0, s8, 2048
    s_nop 0
    buffer_load_dwordx4 v4, s[84:87], s14 offen lds
    s_add_u32 m0, s8, 3072
    s_nop 0
    buffer_load_dwordx4 v5, s[84:87], s14 offen lds
    s_add_u32 s14, s19, 10240
    s_add_u32 m0, s8, 4096
    s_nop 0
    buffer_load_dwordx4 v4, s[84:87], s14 offen lds
    s_add_u32 m0, s8, 5120
    s_nop 0
    buffer_load_dwordx4 v5, s[84:87], s14 offen lds
    s_add_u32 s14, s19, 11264
    s_add_u32 m0, s8, 6144
    s_nop 0
    buffer_load_dwordx4 v4, s[84:87], s14 offen lds
    s_add_u32 m0, s8, 7168
    s_nop 0
    buffer_load_dwordx4 v5, s[84:87], s14 offen lds
    s_branch L1_g2
L1_conv:
    s_setprio 0
    s_load_dwordx8 s[72:79], s[0:1], 8
    s_load_dwordx2 s[80:81], s[0:1], 40
    s_lshl_b32 s10, s2, 1
    s_lshl_b32 s11, s10, 12

    s_add_u32 s20, s16, 0x400000
    s_addc_u32 s21, s17, 0
    s_add_u32 s20, s20, s11
    s_addc_u32 s21, s21, 0
    s_and_b32 s21, s21, 0xffff
    s_mov_b32 s22, 0x2000
    s_mov_b32 s23, 0x20000
    s_add_u32 s32, s16, 0x1000000
    s_addc_u32 s33, s17, 0
    s_add_u32 s32, s32, s11
    s_addc_u32 s33, s33, 0
    s_and_b32 s33, s33, 0xffff
    s_mov_b32 s34, 0x2000
    s_mov_b32 s35, 0x20000
    s_mov_b32 s36, s8
    s_and_b32 s37, s9, 0xffff
    s_mov_b32 s38, 0x400
    s_mov_b32 s39, 0x20000
    s_waitcnt lgkmcnt(0)
    s_mov_b32 s24, s72
    s_and_b32 s25, s73, 0xffff
    s_mov_b32 s26, 0x20000
    s_mov_b32 s27, 0x20000
    s_mov_b32 s28, s74
    s_and_b32 s29, s75, 0xffff
    s_mov_b32 s30, 0x20000
    s_mov_b32 s31, 0x20000
    s_mov_b32 s48, s76
    s_and_b32 s49, s77, 0xffff
    s_mov_b32 s50, 0x20000
    s_mov_b32 s51, 0x20000
    s_mov_b32 s52, s78
    s_and_b32 s53, s79, 0xffff
    s_mov_b32 s54, 0x20000
    s_mov_b32 s55, 0x20000
    s_mov_b32 s56, s80
    s_and_b32 s57, s81, 0xffff
    s_mov_b32 s58, 0x400
    s_mov_b32 s59, 0x20000
    s_lshl_b32 s12, s2, 9
    v_lshl_add_u32 v2, v15, 1, s12
    s_lshl_b32 s12, s2, 2
    v_lshrrev_b32 v3, 7, v15
    v_lshl_add_u32 v3, v3, 1, s12
    buffer_load_ushort v16, v2, s[24:27], 0 offen
    buffer_load_ushort v17, v2, s[28:31], 0 offen
    buffer_load_ushort v18, v2, s[48:51], 0 offen
    buffer_load_ushort v19, v2, s[52:55], 0 offen
    buffer_load_ushort v20, v3, s[56:59], 0 offen

    s_lshr_b32 s14, s3, 1
    s_lshl_b32 s14, s14, 15
    s_and_b32 s15, s3, 1
    s_mul_i32 s15, s15, 8448
    s_add_u32 s14, s14, s15
    s_add_u32 s14, s14, 15360
    v_lshl_add_u32 v2, v0, 3, s14
    v_and_b32 v4, 15, v0
    v_lshrrev_b32 v5, 4, v0
    v_mul_u32_u24 v3, 528, v4
    v_lshl_add_u32 v3, v5, 4, v3
    v_add_u32 v3, s14, v3
    v_mul_u32_u24 v60, 832, v5
    v_lshl_add_u32 v60, v4, 2, v60
    v_add_u32 v60, s14, v60
    v_mov_b32 v6, 0
    v_cmp_le_u32 vcc, 32, v15
    s_nop 1
    v_addc_co_u32 v6, vcc, 0, v6, vcc
    v_cmp_le_u32 vcc, 64, v15
    s_nop 1
    v_addc_co_u32 v6, vcc, 0, v6, vcc
    v_cmp_le_u32 vcc, 128, v15
    s_nop 1
    v_addc_co_u32 v6, vcc, 0, v6, vcc
    v_lshlrev_b32 v7, v6, 1
    v_lshrrev_b32 v7, 1, v7
    v_add_u32 v7, -1, v7
    v_lshlrev_b32 v8, 3, v15
    v_lshlrev_b32 v9, 3, v6
    v_lshrrev_b32 v12, v6, 16
    v_cmp_eq_u32 vcc, 0, v6

    v_add_u32 v10, 0, v8
    v_lshrrev_b32 v11, v6, v10
    v_and_b32 v11, 1, v11
    v_add3_u32 v11, v10, v7, v11
    v_lshrrev_b32 v11, v6, v11
    v_cndmask_b32 v11, v11, v10, vcc
    v_lshlrev_b32 v11, v6, v11
    v_lshrrev_b32 v10, 8, v11
    v_mad_u32_u24 v10, v10, v12, v9
    v_and_b32 v13, 15, v11
    v_lshrrev_b32 v13, v6, v13
    v_add_u32 v10, v10, v13
    v_bfe_u32 v11, v11, 4, 4
    v_mul_u32_u24 v11, 208, v11
    v_lshl_add_u32 v52, v10, 2, v11

    v_add_u32 v10, 1, v8
    v_lshrrev_b32 v11, v6, v10
    v_and_b32 v11, 1, v11
    v_add3_u32 v11, v10, v7, v11
    v_lshrrev_b32 v11, v6, v11
    v_cndmask_b32 v11, v11, v10, vcc
    v_lshlrev_b32 v11, v6, v11
    v_lshrrev_b32 v10, 8, v11
    v_mad_u32_u24 v10, v10, v12, v9
    v_and_b32 v13, 15, v11
    v_lshrrev_b32 v13, v6, v13
    v_add_u32 v10, v10, v13
    v_bfe_u32 v11, v11, 4, 4
    v_mul_u32_u24 v11, 208, v11
    v_lshl_add_u32 v53, v10, 2, v11

    v_add_u32 v10, 2, v8
    v_lshrrev_b32 v11, v6, v10
    v_and_b32 v11, 1, v11
    v_add3_u32 v11, v10, v7, v11
    v_lshrrev_b32 v11, v6, v11
    v_cndmask_b32 v11, v11, v10, vcc
    v_lshlrev_b32 v11, v6, v11
    v_lshrrev_b32 v10, 8, v11
    v_mad_u32_u24 v10, v10, v12, v9
    v_and_b32 v13, 15, v11
    v_lshrrev_b32 v13, v6, v13
    v_add_u32 v10, v10, v13
    v_bfe_u32 v11, v11, 4, 4
    v_mul_u32_u24 v11, 208, v11
    v_lshl_add_u32 v54, v10, 2, v11

    v_add_u32 v10, 3, v8
    v_lshrrev_b32 v11, v6, v10
    v_and_b32 v11, 1, v11
    v_add3_u32 v11, v10, v7, v11
    v_lshrrev_b32 v11, v6, v11
    v_cndmask_b32 v11, v11, v10, vcc
    v_lshlrev_b32 v11, v6, v11
    v_lshrrev_b32 v10, 8, v11
    v_mad_u32_u24 v10, v10, v12, v9
    v_and_b32 v13, 15, v11
    v_lshrrev_b32 v13, v6, v13
    v_add_u32 v10, v10, v13
    v_bfe_u32 v11, v11, 4, 4
    v_mul_u32_u24 v11, 208, v11
    v_lshl_add_u32 v55, v10, 2, v11

    v_add_u32 v10, 4, v8
    v_lshrrev_b32 v11, v6, v10
    v_and_b32 v11, 1, v11
    v_add3_u32 v11, v10, v7, v11
    v_lshrrev_b32 v11, v6, v11
    v_cndmask_b32 v11, v11, v10, vcc
    v_lshlrev_b32 v11, v6, v11
    v_lshrrev_b32 v10, 8, v11
    v_mad_u32_u24 v10, v10, v12, v9
    v_and_b32 v13, 15, v11
    v_lshrrev_b32 v13, v6, v13
    v_add_u32 v10, v10, v13
    v_bfe_u32 v11, v11, 4, 4
    v_mul_u32_u24 v11, 208, v11
    v_lshl_add_u32 v56, v10, 2, v11

    v_add_u32 v10, 5, v8
    v_lshrrev_b32 v11, v6, v10
    v_and_b32 v11, 1, v11
    v_add3_u32 v11, v10, v7, v11
    v_lshrrev_b32 v11, v6, v11
    v_cndmask_b32 v11, v11, v10, vcc
    v_lshlrev_b32 v11, v6, v11
    v_lshrrev_b32 v10, 8, v11
    v_mad_u32_u24 v10, v10, v12, v9
    v_and_b32 v13, 15, v11
    v_lshrrev_b32 v13, v6, v13
    v_add_u32 v10, v10, v13
    v_bfe_u32 v11, v11, 4, 4
    v_mul_u32_u24 v11, 208, v11
    v_lshl_add_u32 v57, v10, 2, v11

    v_add_u32 v10, 6, v8
    v_lshrrev_b32 v11, v6, v10
    v_and_b32 v11, 1, v11
    v_add3_u32 v11, v10, v7, v11
    v_lshrrev_b32 v11, v6, v11
    v_cndmask_b32 v11, v11, v10, vcc
    v_lshlrev_b32 v11, v6, v11
    v_lshrrev_b32 v10, 8, v11
    v_mad_u32_u24 v10, v10, v12, v9
    v_and_b32 v13, 15, v11
    v_lshrrev_b32 v13, v6, v13
    v_add_u32 v10, v10, v13
    v_bfe_u32 v11, v11, 4, 4
    v_mul_u32_u24 v11, 208, v11
    v_lshl_add_u32 v58, v10, 2, v11

    v_add_u32 v10, 7, v8
    v_lshrrev_b32 v11, v6, v10
    v_and_b32 v11, 1, v11
    v_add3_u32 v11, v10, v7, v11
    v_lshrrev_b32 v11, v6, v11
    v_cndmask_b32 v11, v11, v10, vcc
    v_lshlrev_b32 v11, v6, v11
    v_lshrrev_b32 v10, 8, v11
    v_mad_u32_u24 v10, v10, v12, v9
    v_and_b32 v13, 15, v11
    v_lshrrev_b32 v13, v6, v13
    v_add_u32 v10, v10, v13
    v_bfe_u32 v11, v11, 4, 4
    v_mul_u32_u24 v11, 208, v11
    v_lshl_add_u32 v59, v10, 2, v11

    s_waitcnt vmcnt(0)
    v_lshlrev_b32 v16, 16, v16
    v_lshlrev_b32 v17, 16, v17
    v_lshlrev_b32 v18, 16, v18
    v_lshlrev_b32 v19, 16, v19
    v_lshlrev_b32 v20, 16, v20
    v_mul_f32 v16, 0x3fb8aa3b, v16
    v_mul_f32 v20, 0x3fb8aa3b, v20
    v_exp_f32 v16, v16
    v_exp_f32 v20, v20
    s_nop 0
    v_cvt_pk_bf16_f32 v16, v16, v20
    v_and_b32 v20, 0xffff0000, v16
    v_lshlrev_b32 v16, 16, v16
    v_mul_f32 v16, v16, v20
    v_mul_f32 v17, v17, v20
    v_mul_f32 v18, v18, v20
    v_mul_f32 v19, v19, v20
    v_mul_f32 v16, 0xbfb8aa3b, v16
    v_mul_f32 v17, 0x3e22f983, v17
    v_add_f32 v18, v18, v18
    v_mul_f32 v19, -2.0, v19

    v_mul_f32 v20, 0x41800000, v16
    v_mul_f32 v21, 0x41800000, v17
    v_exp_f32 v20, v20
    v_cos_f32 v184, v21
    v_sin_f32 v185, -v21
    v_mul_f32 v22, 0x42800000, v16
    v_mul_f32 v23, 0x42800000, v17
    v_exp_f32 v22, v22
    v_cos_f32 v186, v23
    v_sin_f32 v187, -v23
    v_mul_f32 v24, 0x43000000, v16
    v_mul_f32 v25, 0x43000000, v17
    v_exp_f32 v24, v24
    v_cos_f32 v188, v25
    v_sin_f32 v189, -v25
    v_mul_f32 v26, 0x3f800000, v16
    v_mul_f32 v27, 0x3f800000, v17
    v_exp_f32 v26, v26
    v_cos_f32 v190, v27
    v_sin_f32 v191, v27
    v_mul_f32 v28, 0x40800000, v16
    v_mul_f32 v29, 0x40800000, v17
    v_exp_f32 v28, v28
    v_cos_f32 v192, v29
    v_sin_f32 v193, v29
    v_mul_f32 v30, 0x41000000, v16
    v_mul_f32 v31, 0x41000000, v17
    v_exp_f32 v30, v30
    v_cos_f32 v194, v31
    v_sin_f32 v195, v31
    v_mul_f32 v32, 0x43800000, v16
    v_mul_f32 v33, 0x43800000, v17
    v_exp_f32 v32, v32
    v_cos_f32 v196, v33
    v_sin_f32 v197, v33
    v_mul_f32 v34, 0x44000000, v16
    v_mul_f32 v35, 0x44000000, v17
    v_exp_f32 v34, v34
    v_cos_f32 v198, v35
    v_sin_f32 v199, v35
    v_mul_f32 v36, 0x44800000, v16
    v_mul_f32 v37, 0x44800000, v17
    v_exp_f32 v36, v36
    v_cos_f32 v200, v37
    v_sin_f32 v201, v37
    s_nop 0
    v_mul_f32_e32 v184, v184, v20
    v_mul_f32_e32 v185, v185, v20
    v_mul_f32_e32 v186, v186, v22
    v_mul_f32_e32 v187, v187, v22
    v_mul_f32_e32 v188, v188, v24
    v_mul_f32_e32 v189, v189, v24
    v_mul_f32_e32 v190, v190, v26
    v_mul_f32_e32 v191, v191, v26
    v_mul_f32_e32 v192, v192, v28
    v_mul_f32_e32 v193, v193, v28
    v_mul_f32_e32 v194, v194, v30
    v_mul_f32_e32 v195, v195, v30
    v_mul_f32_e32 v196, v196, v32
    v_mul_f32_e32 v197, v197, v32
    v_mul_f32_e32 v198, v198, v34
    v_mul_f32_e32 v199, v199, v34
    v_mul_f32_e32 v200, v200, v36
    v_mul_f32_e32 v201, v201, v36
    v_mul_f32_e32 v202, v185, v185
    v_mul_f32_e32 v203, v184, v185
    v_fma_f32 v202, v184, v184, -v202
    v_fmac_f32_e32 v203, v185, v184
    v_mul_f32_e32 v204, v203, v185
    v_mul_f32_e32 v205, v202, v185
    v_fma_f32 v204, v202, v184, -v204
    v_fmac_f32_e32 v205, v203, v184
    v_mul_f32_e32 v206, v189, v187
    v_mul_f32_e32 v207, v188, v187
    v_fma_f32 v206, v188, v186, -v206
    v_fmac_f32_e32 v207, v189, v186
    v_cvt_pk_bf16_f32 v44, v18, v19
    v_lshlrev_b32 v48, 16, v44
    v_and_b32 v49, 0xffff0000, v44
    v_sub_f32_e32 v48, v18, v48
    v_sub_f32_e32 v49, v19, v49
    v_cvt_pk_bf16_f32 v45, v48, v49
    ds_write_b64 v2, v[44:45] offset:0

    v_mul_f32_e32 v208, v19, v185
    v_mul_f32_e32 v209, v18, v185
    v_fma_f32 v208, v18, v184, -v208
    v_fmac_f32_e32 v209, v19, v184
    v_cvt_pk_bf16_f32 v46, v208, v209
    v_lshlrev_b32 v50, 16, v46
    v_and_b32 v51, 0xffff0000, v46
    v_sub_f32_e32 v50, v208, v50
    v_sub_f32_e32 v51, v209, v51
    v_cvt_pk_bf16_f32 v47, v50, v51
    ds_write_b64 v2, v[46:47] offset:528

    v_mul_f32_e32 v210, v19, v203
    v_mul_f32_e32 v211, v18, v203
    v_fma_f32 v210, v18, v202, -v210
    v_fmac_f32_e32 v211, v19, v202
    v_cvt_pk_bf16_f32 v44, v210, v211
    v_lshlrev_b32 v48, 16, v44
    v_and_b32 v49, 0xffff0000, v44
    v_sub_f32_e32 v48, v210, v48
    v_sub_f32_e32 v49, v211, v49
    v_cvt_pk_bf16_f32 v45, v48, v49
    ds_write_b64 v2, v[44:45] offset:1056

    v_mul_f32_e32 v208, v19, v205
    v_mul_f32_e32 v209, v18, v205
    v_fma_f32 v208, v18, v204, -v208
    v_fmac_f32_e32 v209, v19, v204
    v_cvt_pk_bf16_f32 v46, v208, v209
    v_lshlrev_b32 v50, 16, v46
    v_and_b32 v51, 0xffff0000, v46
    v_sub_f32_e32 v50, v208, v50
    v_sub_f32_e32 v51, v209, v51
    v_cvt_pk_bf16_f32 v47, v50, v51
    ds_write_b64 v2, v[46:47] offset:1584

    v_mul_f32_e32 v212, v19, v187
    v_mul_f32_e32 v213, v18, v187
    v_fma_f32 v212, v18, v186, -v212
    v_fmac_f32_e32 v213, v19, v186
    v_cvt_pk_bf16_f32 v44, v212, v213
    v_lshlrev_b32 v48, 16, v44
    v_and_b32 v49, 0xffff0000, v44
    v_sub_f32_e32 v48, v212, v48
    v_sub_f32_e32 v49, v213, v49
    v_cvt_pk_bf16_f32 v45, v48, v49
    ds_write_b64 v2, v[44:45] offset:2112

    v_mul_f32_e32 v208, v213, v185
    v_mul_f32_e32 v209, v212, v185
    v_fma_f32 v208, v212, v184, -v208
    v_fmac_f32_e32 v209, v213, v184
    v_cvt_pk_bf16_f32 v46, v208, v209
    v_lshlrev_b32 v50, 16, v46
    v_and_b32 v51, 0xffff0000, v46
    v_sub_f32_e32 v50, v208, v50
    v_sub_f32_e32 v51, v209, v51
    v_cvt_pk_bf16_f32 v47, v50, v51
    ds_write_b64 v2, v[46:47] offset:2640

    v_mul_f32_e32 v210, v213, v203
    v_mul_f32_e32 v211, v212, v203
    v_fma_f32 v210, v212, v202, -v210
    v_fmac_f32_e32 v211, v213, v202
    v_cvt_pk_bf16_f32 v44, v210, v211
    v_lshlrev_b32 v48, 16, v44
    v_and_b32 v49, 0xffff0000, v44
    v_sub_f32_e32 v48, v210, v48
    v_sub_f32_e32 v49, v211, v49
    v_cvt_pk_bf16_f32 v45, v48, v49
    ds_write_b64 v2, v[44:45] offset:3168

    v_mul_f32_e32 v208, v213, v205
    v_mul_f32_e32 v209, v212, v205
    v_fma_f32 v208, v212, v204, -v208
    v_fmac_f32_e32 v209, v213, v204
    v_cvt_pk_bf16_f32 v46, v208, v209
    v_lshlrev_b32 v50, 16, v46
    v_and_b32 v51, 0xffff0000, v46
    v_sub_f32_e32 v50, v208, v50
    v_sub_f32_e32 v51, v209, v51
    v_cvt_pk_bf16_f32 v47, v50, v51
    ds_write_b64 v2, v[46:47] offset:3696

    v_mul_f32_e32 v212, v19, v189
    v_mul_f32_e32 v213, v18, v189
    v_fma_f32 v212, v18, v188, -v212
    v_fmac_f32_e32 v213, v19, v188
    v_cvt_pk_bf16_f32 v44, v212, v213
    v_lshlrev_b32 v48, 16, v44
    v_and_b32 v49, 0xffff0000, v44
    v_sub_f32_e32 v48, v212, v48
    v_sub_f32_e32 v49, v213, v49
    v_cvt_pk_bf16_f32 v45, v48, v49
    ds_write_b64 v2, v[44:45] offset:4224

    v_mul_f32_e32 v208, v213, v185
    v_mul_f32_e32 v209, v212, v185
    v_fma_f32 v208, v212, v184, -v208
    v_fmac_f32_e32 v209, v213, v184
    v_cvt_pk_bf16_f32 v46, v208, v209
    v_lshlrev_b32 v50, 16, v46
    v_and_b32 v51, 0xffff0000, v46
    v_sub_f32_e32 v50, v208, v50
    v_sub_f32_e32 v51, v209, v51
    v_cvt_pk_bf16_f32 v47, v50, v51
    ds_write_b64 v2, v[46:47] offset:4752

    v_mul_f32_e32 v210, v213, v203
    v_mul_f32_e32 v211, v212, v203
    v_fma_f32 v210, v212, v202, -v210
    v_fmac_f32_e32 v211, v213, v202
    v_cvt_pk_bf16_f32 v44, v210, v211
    v_lshlrev_b32 v48, 16, v44
    v_and_b32 v49, 0xffff0000, v44
    v_sub_f32_e32 v48, v210, v48
    v_sub_f32_e32 v49, v211, v49
    v_cvt_pk_bf16_f32 v45, v48, v49
    ds_write_b64 v2, v[44:45] offset:5280

    v_mul_f32_e32 v208, v213, v205
    v_mul_f32_e32 v209, v212, v205
    v_fma_f32 v208, v212, v204, -v208
    v_fmac_f32_e32 v209, v213, v204
    v_cvt_pk_bf16_f32 v46, v208, v209
    v_lshlrev_b32 v50, 16, v46
    v_and_b32 v51, 0xffff0000, v46
    v_sub_f32_e32 v50, v208, v50
    v_sub_f32_e32 v51, v209, v51
    v_cvt_pk_bf16_f32 v47, v50, v51
    ds_write_b64 v2, v[46:47] offset:5808

    v_mul_f32_e32 v212, v19, v207
    v_mul_f32_e32 v213, v18, v207
    v_fma_f32 v212, v18, v206, -v212
    v_fmac_f32_e32 v213, v19, v206
    v_cvt_pk_bf16_f32 v44, v212, v213
    v_lshlrev_b32 v48, 16, v44
    v_and_b32 v49, 0xffff0000, v44
    v_sub_f32_e32 v48, v212, v48
    v_sub_f32_e32 v49, v213, v49
    v_cvt_pk_bf16_f32 v45, v48, v49
    ds_write_b64 v2, v[44:45] offset:6336

    v_mul_f32_e32 v208, v213, v185
    v_mul_f32_e32 v209, v212, v185
    v_fma_f32 v208, v212, v184, -v208
    v_fmac_f32_e32 v209, v213, v184
    v_cvt_pk_bf16_f32 v46, v208, v209
    v_lshlrev_b32 v50, 16, v46
    v_and_b32 v51, 0xffff0000, v46
    v_sub_f32_e32 v50, v208, v50
    v_sub_f32_e32 v51, v209, v51
    v_cvt_pk_bf16_f32 v47, v50, v51
    ds_write_b64 v2, v[46:47] offset:6864

    v_mul_f32_e32 v210, v213, v203
    v_mul_f32_e32 v211, v212, v203
    v_fma_f32 v210, v212, v202, -v210
    v_fmac_f32_e32 v211, v213, v202
    v_cvt_pk_bf16_f32 v44, v210, v211
    v_lshlrev_b32 v48, 16, v44
    v_and_b32 v49, 0xffff0000, v44
    v_sub_f32_e32 v48, v210, v48
    v_sub_f32_e32 v49, v211, v49
    v_cvt_pk_bf16_f32 v45, v48, v49
    ds_write_b64 v2, v[44:45] offset:7392

    v_mul_f32_e32 v208, v213, v205
    v_mul_f32_e32 v209, v212, v205
    v_fma_f32 v208, v212, v204, -v208
    v_fmac_f32_e32 v209, v213, v204
    v_cvt_pk_bf16_f32 v46, v208, v209
    v_lshlrev_b32 v50, 16, v46
    v_and_b32 v51, 0xffff0000, v46
    v_sub_f32_e32 v50, v208, v50
    v_sub_f32_e32 v51, v209, v51
    v_cvt_pk_bf16_f32 v47, v50, v51
    ds_write_b64 v2, v[46:47] offset:7920

    ds_read_b128 v[64:67], v3 offset:0
    ds_read2_b32 v[96:97], v3 offset0:1 offset1:0
    ds_read2_b32 v[98:99], v3 offset0:3 offset1:2
    ds_read_b128 v[68:71], v3 offset:64
    ds_read2_b32 v[100:101], v3 offset0:17 offset1:16
    ds_read2_b32 v[102:103], v3 offset0:19 offset1:18
    ds_read_b128 v[72:75], v3 offset:128
    ds_read2_b32 v[104:105], v3 offset0:33 offset1:32
    ds_read2_b32 v[106:107], v3 offset0:35 offset1:34
    ds_read_b128 v[76:79], v3 offset:192
    ds_read2_b32 v[108:109], v3 offset0:49 offset1:48
    ds_read2_b32 v[110:111], v3 offset0:51 offset1:50
    ds_read_b128 v[80:83], v3 offset:256
    ds_read2_b32 v[112:113], v3 offset0:65 offset1:64
    ds_read2_b32 v[114:115], v3 offset0:67 offset1:66
    ds_read_b128 v[84:87], v3 offset:320
    ds_read2_b32 v[116:117], v3 offset0:81 offset1:80
    ds_read2_b32 v[118:119], v3 offset0:83 offset1:82
    ds_read_b128 v[88:91], v3 offset:384
    ds_read2_b32 v[120:121], v3 offset0:97 offset1:96
    ds_read2_b32 v[122:123], v3 offset0:99 offset1:98
    ds_read_b128 v[92:95], v3 offset:448
    ds_read2_b32 v[124:125], v3 offset0:113 offset1:112
    ds_read2_b32 v[126:127], v3 offset0:115 offset1:114
    v_mov_b32 v214, 1.0
    v_mov_b32 v215, 0
    v_mul_f32_e32 v216, v191, v191
    v_mul_f32_e32 v217, v190, v191
    v_fma_f32 v216, v190, v190, -v216
    v_fmac_f32_e32 v217, v191, v190
    v_mul_f32_e32 v218, v217, v191
    v_mul_f32_e32 v219, v216, v191
    v_fma_f32 v218, v216, v190, -v218
    v_fmac_f32_e32 v219, v217, v190
    v_mul_f32_e32 v220, v195, v193
    v_mul_f32_e32 v221, v194, v193
    v_fma_f32 v220, v194, v192, -v220
    v_fmac_f32_e32 v221, v195, v192
    v_cvt_pk_bf16_f32 v44, v214, v215
    v_lshlrev_b32 v48, 16, v44
    v_and_b32 v49, 0xffff0000, v44
    v_sub_f32_e32 v48, v214, v48
    v_sub_f32_e32 v49, v215, v49
    v_cvt_pk_bf16_f32 v45, v48, v49
    ds_write_b64 v2, v[44:45] offset:0

    v_cvt_pk_bf16_f32 v46, v190, v191
    v_lshlrev_b32 v50, 16, v46
    v_and_b32 v51, 0xffff0000, v46
    v_sub_f32_e32 v50, v190, v50
    v_sub_f32_e32 v51, v191, v51
    v_cvt_pk_bf16_f32 v47, v50, v51
    ds_write_b64 v2, v[46:47] offset:528

    v_cvt_pk_bf16_f32 v44, v216, v217
    v_lshlrev_b32 v48, 16, v44
    v_and_b32 v49, 0xffff0000, v44
    v_sub_f32_e32 v48, v216, v48
    v_sub_f32_e32 v49, v217, v49
    v_cvt_pk_bf16_f32 v45, v48, v49
    ds_write_b64 v2, v[44:45] offset:1056

    v_cvt_pk_bf16_f32 v46, v218, v219
    v_lshlrev_b32 v50, 16, v46
    v_and_b32 v51, 0xffff0000, v46
    v_sub_f32_e32 v50, v218, v50
    v_sub_f32_e32 v51, v219, v51
    v_cvt_pk_bf16_f32 v47, v50, v51
    ds_write_b64 v2, v[46:47] offset:1584

    v_cvt_pk_bf16_f32 v44, v192, v193
    v_lshlrev_b32 v48, 16, v44
    v_and_b32 v49, 0xffff0000, v44
    v_sub_f32_e32 v48, v192, v48
    v_sub_f32_e32 v49, v193, v49
    v_cvt_pk_bf16_f32 v45, v48, v49
    ds_write_b64 v2, v[44:45] offset:2112

    v_mul_f32_e32 v210, v193, v191
    v_mul_f32_e32 v211, v192, v191
    v_fma_f32 v210, v192, v190, -v210
    v_fmac_f32_e32 v211, v193, v190
    v_cvt_pk_bf16_f32 v46, v210, v211
    v_lshlrev_b32 v50, 16, v46
    v_and_b32 v51, 0xffff0000, v46
    v_sub_f32_e32 v50, v210, v50
    v_sub_f32_e32 v51, v211, v51
    v_cvt_pk_bf16_f32 v47, v50, v51
    ds_write_b64 v2, v[46:47] offset:2640

    v_mul_f32_e32 v222, v193, v217
    v_mul_f32_e32 v223, v192, v217
    v_fma_f32 v222, v192, v216, -v222
    v_fmac_f32_e32 v223, v193, v216
    v_cvt_pk_bf16_f32 v44, v222, v223
    v_lshlrev_b32 v48, 16, v44
    v_and_b32 v49, 0xffff0000, v44
    v_sub_f32_e32 v48, v222, v48
    v_sub_f32_e32 v49, v223, v49
    v_cvt_pk_bf16_f32 v45, v48, v49
    ds_write_b64 v2, v[44:45] offset:3168

    v_mul_f32_e32 v208, v193, v219
    v_mul_f32_e32 v209, v192, v219
    v_fma_f32 v208, v192, v218, -v208
    v_fmac_f32_e32 v209, v193, v218
    v_cvt_pk_bf16_f32 v46, v208, v209
    v_lshlrev_b32 v50, 16, v46
    v_and_b32 v51, 0xffff0000, v46
    v_sub_f32_e32 v50, v208, v50
    v_sub_f32_e32 v51, v209, v51
    v_cvt_pk_bf16_f32 v47, v50, v51
    ds_write_b64 v2, v[46:47] offset:3696

    v_cvt_pk_bf16_f32 v44, v194, v195
    v_lshlrev_b32 v48, 16, v44
    v_and_b32 v49, 0xffff0000, v44
    v_sub_f32_e32 v48, v194, v48
    v_sub_f32_e32 v49, v195, v49
    v_cvt_pk_bf16_f32 v45, v48, v49
    ds_write_b64 v2, v[44:45] offset:4224

    v_mul_f32_e32 v210, v195, v191
    v_mul_f32_e32 v211, v194, v191
    v_fma_f32 v210, v194, v190, -v210
    v_fmac_f32_e32 v211, v195, v190
    v_cvt_pk_bf16_f32 v46, v210, v211
    v_lshlrev_b32 v50, 16, v46
    v_and_b32 v51, 0xffff0000, v46
    v_sub_f32_e32 v50, v210, v50
    v_sub_f32_e32 v51, v211, v51
    v_cvt_pk_bf16_f32 v47, v50, v51
    ds_write_b64 v2, v[46:47] offset:4752

    v_mul_f32_e32 v224, v195, v217
    v_mul_f32_e32 v225, v194, v217
    v_fma_f32 v224, v194, v216, -v224
    v_fmac_f32_e32 v225, v195, v216
    v_cvt_pk_bf16_f32 v44, v224, v225
    v_lshlrev_b32 v48, 16, v44
    v_and_b32 v49, 0xffff0000, v44
    v_sub_f32_e32 v48, v224, v48
    v_sub_f32_e32 v49, v225, v49
    v_cvt_pk_bf16_f32 v45, v48, v49
    ds_write_b64 v2, v[44:45] offset:5280

    v_mul_f32_e32 v208, v195, v219
    v_mul_f32_e32 v209, v194, v219
    v_fma_f32 v208, v194, v218, -v208
    v_fmac_f32_e32 v209, v195, v218
    v_cvt_pk_bf16_f32 v46, v208, v209
    v_lshlrev_b32 v50, 16, v46
    v_and_b32 v51, 0xffff0000, v46
    v_sub_f32_e32 v50, v208, v50
    v_sub_f32_e32 v51, v209, v51
    v_cvt_pk_bf16_f32 v47, v50, v51
    ds_write_b64 v2, v[46:47] offset:5808

    v_cvt_pk_bf16_f32 v44, v220, v221
    v_lshlrev_b32 v48, 16, v44
    v_and_b32 v49, 0xffff0000, v44
    v_sub_f32_e32 v48, v220, v48
    v_sub_f32_e32 v49, v221, v49
    v_cvt_pk_bf16_f32 v45, v48, v49
    ds_write_b64 v2, v[44:45] offset:6336

    v_mul_f32_e32 v210, v221, v191
    v_mul_f32_e32 v211, v220, v191
    v_fma_f32 v210, v220, v190, -v210
    v_fmac_f32_e32 v211, v221, v190
    v_cvt_pk_bf16_f32 v46, v210, v211
    v_lshlrev_b32 v50, 16, v46
    v_and_b32 v51, 0xffff0000, v46
    v_sub_f32_e32 v50, v210, v50
    v_sub_f32_e32 v51, v211, v51
    v_cvt_pk_bf16_f32 v47, v50, v51
    ds_write_b64 v2, v[46:47] offset:6864

    v_mul_f32_e32 v226, v221, v217
    v_mul_f32_e32 v227, v220, v217
    v_fma_f32 v226, v220, v216, -v226
    v_fmac_f32_e32 v227, v221, v216
    v_cvt_pk_bf16_f32 v44, v226, v227
    v_lshlrev_b32 v48, 16, v44
    v_and_b32 v49, 0xffff0000, v44
    v_sub_f32_e32 v48, v226, v48
    v_sub_f32_e32 v49, v227, v49
    v_cvt_pk_bf16_f32 v45, v48, v49
    ds_write_b64 v2, v[44:45] offset:7392

    v_mul_f32_e32 v208, v221, v219
    v_mul_f32_e32 v209, v220, v219
    v_fma_f32 v208, v220, v218, -v208
    v_fmac_f32_e32 v209, v221, v218
    v_cvt_pk_bf16_f32 v46, v208, v209
    v_lshlrev_b32 v50, 16, v46
    v_and_b32 v51, 0xffff0000, v46
    v_sub_f32_e32 v50, v208, v50
    v_sub_f32_e32 v51, v209, v51
    v_cvt_pk_bf16_f32 v47, v50, v51
    ds_write_b64 v2, v[46:47] offset:7920

    ds_read_b128 v[128:131], v3 offset:0
    ds_read_b128 v[132:135], v3 offset:64
    ds_read_b128 v[136:139], v3 offset:128
    ds_read_b128 v[140:143], v3 offset:192
    ds_read_b128 v[144:147], v3 offset:256
    ds_read_b128 v[148:151], v3 offset:320
    ds_read_b128 v[152:155], v3 offset:384
    ds_read_b128 v[156:159], v3 offset:448
    v_mov_b32 v248, -1
    v_mov_b32 v249, -1
    v_mov_b32 v250, -1
    v_mov_b32 v251, -1
    v_lshlrev_b32 v252, 4, v15
    s_mov_b32 s44, 4096
    buffer_store_dwordx4 v[248:251], v252, s[32:35], 0 offen sc1
    buffer_store_dwordx4 v[248:251], v252, s[32:35], s44 offen sc1

    v_mul_f32_e32 v228, v199, v197
    v_mul_f32_e32 v229, v198, v197
    v_fma_f32 v228, v198, v196, -v228
    v_fmac_f32_e32 v229, v199, v196
    v_cvt_pk_bf16_f32 v44, v196, v197
    v_lshlrev_b32 v48, 16, v44
    v_and_b32 v49, 0xffff0000, v44
    v_sub_f32_e32 v48, v196, v48
    v_sub_f32_e32 v49, v197, v49
    v_cvt_pk_bf16_f32 v45, v48, v49
    ds_write_b64 v2, v[44:45] offset:0

    v_mul_f32_e32 v208, v197, v217
    v_mul_f32_e32 v209, v196, v217
    v_fma_f32 v208, v196, v216, -v208
    v_fmac_f32_e32 v209, v197, v216
    v_cvt_pk_bf16_f32 v46, v208, v209
    v_lshlrev_b32 v50, 16, v46
    v_and_b32 v51, 0xffff0000, v46
    v_sub_f32_e32 v50, v208, v50
    v_sub_f32_e32 v51, v209, v51
    v_cvt_pk_bf16_f32 v47, v50, v51
    ds_write_b64 v2, v[46:47] offset:528

    v_mul_f32_e32 v210, v197, v193
    v_mul_f32_e32 v211, v196, v193
    v_fma_f32 v210, v196, v192, -v210
    v_fmac_f32_e32 v211, v197, v192
    v_cvt_pk_bf16_f32 v44, v210, v211
    v_lshlrev_b32 v48, 16, v44
    v_and_b32 v49, 0xffff0000, v44
    v_sub_f32_e32 v48, v210, v48
    v_sub_f32_e32 v49, v211, v49
    v_cvt_pk_bf16_f32 v45, v48, v49
    ds_write_b64 v2, v[44:45] offset:1056

    v_mul_f32_e32 v208, v197, v223
    v_mul_f32_e32 v209, v196, v223
    v_fma_f32 v208, v196, v222, -v208
    v_fmac_f32_e32 v209, v197, v222
    v_cvt_pk_bf16_f32 v46, v208, v209
    v_lshlrev_b32 v50, 16, v46
    v_and_b32 v51, 0xffff0000, v46
    v_sub_f32_e32 v50, v208, v50
    v_sub_f32_e32 v51, v209, v51
    v_cvt_pk_bf16_f32 v47, v50, v51
    ds_write_b64 v2, v[46:47] offset:1584

    s_waitcnt lgkmcnt(4)
    v_mfma_f32_16x16x32_bf16 v[160:163], v[64:67], v[128:131], 0
    v_mfma_f32_16x16x32_bf16 v[164:167], v[96:99], v[128:131], 0
    v_mfma_f32_16x16x32_bf16 v[160:163], v[68:71], v[132:135], v[160:163]
    v_mfma_f32_16x16x32_bf16 v[164:167], v[100:103], v[132:135], v[164:167]
    v_mfma_f32_16x16x32_bf16 v[160:163], v[72:75], v[136:139], v[160:163]
    v_mfma_f32_16x16x32_bf16 v[164:167], v[104:107], v[136:139], v[164:167]
    v_mfma_f32_16x16x32_bf16 v[160:163], v[76:79], v[140:143], v[160:163]
    v_mfma_f32_16x16x32_bf16 v[164:167], v[108:111], v[140:143], v[164:167]
    v_mfma_f32_16x16x32_bf16 v[160:163], v[80:83], v[144:147], v[160:163]
    v_mfma_f32_16x16x32_bf16 v[164:167], v[112:115], v[144:147], v[164:167]
    v_mfma_f32_16x16x32_bf16 v[160:163], v[84:87], v[148:151], v[160:163]
    v_mfma_f32_16x16x32_bf16 v[164:167], v[116:119], v[148:151], v[164:167]
    v_mfma_f32_16x16x32_bf16 v[160:163], v[88:91], v[152:155], v[160:163]
    v_mfma_f32_16x16x32_bf16 v[164:167], v[120:123], v[152:155], v[164:167]
    v_mfma_f32_16x16x32_bf16 v[160:163], v[92:95], v[156:159], v[160:163]
    v_mfma_f32_16x16x32_bf16 v[164:167], v[124:127], v[156:159], v[164:167]
    v_mul_f32_e32 v210, v197, v195
    v_mul_f32_e32 v211, v196, v195
    v_fma_f32 v210, v196, v194, -v210
    v_fmac_f32_e32 v211, v197, v194
    v_cvt_pk_bf16_f32 v44, v210, v211
    v_lshlrev_b32 v48, 16, v44
    v_and_b32 v49, 0xffff0000, v44
    v_sub_f32_e32 v48, v210, v48
    v_sub_f32_e32 v49, v211, v49
    v_cvt_pk_bf16_f32 v45, v48, v49
    ds_write_b64 v2, v[44:45] offset:2112

    v_mul_f32_e32 v208, v197, v225
    v_mul_f32_e32 v209, v196, v225
    v_fma_f32 v208, v196, v224, -v208
    v_fmac_f32_e32 v209, v197, v224
    v_cvt_pk_bf16_f32 v46, v208, v209
    v_lshlrev_b32 v50, 16, v46
    v_and_b32 v51, 0xffff0000, v46
    v_sub_f32_e32 v50, v208, v50
    v_sub_f32_e32 v51, v209, v51
    v_cvt_pk_bf16_f32 v47, v50, v51
    ds_write_b64 v2, v[46:47] offset:2640

    v_mul_f32_e32 v210, v197, v221
    v_mul_f32_e32 v211, v196, v221
    v_fma_f32 v210, v196, v220, -v210
    v_fmac_f32_e32 v211, v197, v220
    v_cvt_pk_bf16_f32 v44, v210, v211
    v_lshlrev_b32 v48, 16, v44
    v_and_b32 v49, 0xffff0000, v44
    v_sub_f32_e32 v48, v210, v48
    v_sub_f32_e32 v49, v211, v49
    v_cvt_pk_bf16_f32 v45, v48, v49
    ds_write_b64 v2, v[44:45] offset:3168

    v_mul_f32_e32 v208, v197, v227
    v_mul_f32_e32 v209, v196, v227
    v_fma_f32 v208, v196, v226, -v208
    v_fmac_f32_e32 v209, v197, v226
    v_cvt_pk_bf16_f32 v46, v208, v209
    v_lshlrev_b32 v50, 16, v46
    v_and_b32 v51, 0xffff0000, v46
    v_sub_f32_e32 v50, v208, v50
    v_sub_f32_e32 v51, v209, v51
    v_cvt_pk_bf16_f32 v47, v50, v51
    ds_write_b64 v2, v[46:47] offset:3696

    v_cvt_pk_bf16_f32 v44, v198, v199
    v_lshlrev_b32 v48, 16, v44
    v_and_b32 v49, 0xffff0000, v44
    v_sub_f32_e32 v48, v198, v48
    v_sub_f32_e32 v49, v199, v49
    v_cvt_pk_bf16_f32 v45, v48, v49
    ds_write_b64 v2, v[44:45] offset:4224

    v_mul_f32_e32 v208, v199, v193
    v_mul_f32_e32 v209, v198, v193
    v_fma_f32 v208, v198, v192, -v208
    v_fmac_f32_e32 v209, v199, v192
    v_cvt_pk_bf16_f32 v46, v208, v209
    v_lshlrev_b32 v50, 16, v46
    v_and_b32 v51, 0xffff0000, v46
    v_sub_f32_e32 v50, v208, v50
    v_sub_f32_e32 v51, v209, v51
    v_cvt_pk_bf16_f32 v47, v50, v51
    ds_write_b64 v2, v[46:47] offset:4752

    v_mul_f32_e32 v210, v199, v195
    v_mul_f32_e32 v211, v198, v195
    v_fma_f32 v210, v198, v194, -v210
    v_fmac_f32_e32 v211, v199, v194
    v_cvt_pk_bf16_f32 v44, v210, v211
    v_lshlrev_b32 v48, 16, v44
    v_and_b32 v49, 0xffff0000, v44
    v_sub_f32_e32 v48, v210, v48
    v_sub_f32_e32 v49, v211, v49
    v_cvt_pk_bf16_f32 v45, v48, v49
    ds_write_b64 v2, v[44:45] offset:5280

    v_mul_f32_e32 v208, v199, v221
    v_mul_f32_e32 v209, v198, v221
    v_fma_f32 v208, v198, v220, -v208
    v_fmac_f32_e32 v209, v199, v220
    v_cvt_pk_bf16_f32 v46, v208, v209
    v_lshlrev_b32 v50, 16, v46
    v_and_b32 v51, 0xffff0000, v46
    v_sub_f32_e32 v50, v208, v50
    v_sub_f32_e32 v51, v209, v51
    v_cvt_pk_bf16_f32 v47, v50, v51
    ds_write_b64 v2, v[46:47] offset:5808

    v_cvt_pk_bf16_f32 v44, v228, v229
    v_lshlrev_b32 v48, 16, v44
    v_and_b32 v49, 0xffff0000, v44
    v_sub_f32_e32 v48, v228, v48
    v_sub_f32_e32 v49, v229, v49
    v_cvt_pk_bf16_f32 v45, v48, v49
    ds_write_b64 v2, v[44:45] offset:6336

    v_mul_f32_e32 v208, v229, v193
    v_mul_f32_e32 v209, v228, v193
    v_fma_f32 v208, v228, v192, -v208
    v_fmac_f32_e32 v209, v229, v192
    v_cvt_pk_bf16_f32 v46, v208, v209
    v_lshlrev_b32 v50, 16, v46
    v_and_b32 v51, 0xffff0000, v46
    v_sub_f32_e32 v50, v208, v50
    v_sub_f32_e32 v51, v209, v51
    v_cvt_pk_bf16_f32 v47, v50, v51
    ds_write_b64 v2, v[46:47] offset:6864

    v_mul_f32_e32 v210, v229, v195
    v_mul_f32_e32 v211, v228, v195
    v_fma_f32 v210, v228, v194, -v210
    v_fmac_f32_e32 v211, v229, v194
    v_cvt_pk_bf16_f32 v44, v210, v211
    v_lshlrev_b32 v48, 16, v44
    v_and_b32 v49, 0xffff0000, v44
    v_sub_f32_e32 v48, v210, v48
    v_sub_f32_e32 v49, v211, v49
    v_cvt_pk_bf16_f32 v45, v48, v49
    ds_write_b64 v2, v[44:45] offset:7392

    v_mul_f32_e32 v208, v229, v221
    v_mul_f32_e32 v209, v228, v221
    v_fma_f32 v208, v228, v220, -v208
    v_fmac_f32_e32 v209, v229, v220
    v_cvt_pk_bf16_f32 v46, v208, v209
    v_lshlrev_b32 v50, 16, v46
    v_and_b32 v51, 0xffff0000, v46
    v_sub_f32_e32 v50, v208, v50
    v_sub_f32_e32 v51, v209, v51
    v_cvt_pk_bf16_f32 v47, v50, v51
    ds_write_b64 v2, v[46:47] offset:7920

    ds_read_b128 v[128:131], v3 offset:0
    ds_read_b128 v[132:135], v3 offset:64
    ds_read_b128 v[136:139], v3 offset:128
    ds_read_b128 v[140:143], v3 offset:192
    ds_read_b128 v[144:147], v3 offset:256
    ds_read_b128 v[148:151], v3 offset:320
    ds_read_b128 v[152:155], v3 offset:384
    ds_read_b128 v[156:159], v3 offset:448
    v_mul_f32_e32 v230, v201, v197
    v_mul_f32_e32 v231, v200, v197
    v_fma_f32 v230, v200, v196, -v230
    v_fmac_f32_e32 v231, v201, v196
    v_mul_f32_e32 v232, v201, v199
    v_mul_f32_e32 v233, v200, v199
    v_fma_f32 v232, v200, v198, -v232
    v_fmac_f32_e32 v233, v201, v198
    v_mul_f32_e32 v234, v201, v229
    v_mul_f32_e32 v235, v200, v229
    v_fma_f32 v234, v200, v228, -v234
    v_fmac_f32_e32 v235, v201, v228
    v_mul_f32_e32 v236, v201, v201
    v_mul_f32_e32 v237, v200, v201
    v_fma_f32 v236, v200, v200, -v236
    v_fmac_f32_e32 v237, v201, v200
    v_cvt_pk_bf16_f32 v44, v200, v201
    v_lshlrev_b32 v48, 16, v44
    v_and_b32 v49, 0xffff0000, v44
    v_sub_f32_e32 v48, v200, v48
    v_sub_f32_e32 v49, v201, v49
    v_cvt_pk_bf16_f32 v45, v48, v49
    ds_write_b64 v2, v[44:45] offset:0

    v_mul_f32_e32 v208, v201, v195
    v_mul_f32_e32 v209, v200, v195
    v_fma_f32 v208, v200, v194, -v208
    v_fmac_f32_e32 v209, v201, v194
    v_cvt_pk_bf16_f32 v46, v208, v209
    v_lshlrev_b32 v50, 16, v46
    v_and_b32 v51, 0xffff0000, v46
    v_sub_f32_e32 v50, v208, v50
    v_sub_f32_e32 v51, v209, v51
    v_cvt_pk_bf16_f32 v47, v50, v51
    ds_write_b64 v2, v[46:47] offset:528

    v_cvt_pk_bf16_f32 v44, v230, v231
    v_lshlrev_b32 v48, 16, v44
    v_and_b32 v49, 0xffff0000, v44
    v_sub_f32_e32 v48, v230, v48
    v_sub_f32_e32 v49, v231, v49
    v_cvt_pk_bf16_f32 v45, v48, v49
    ds_write_b64 v2, v[44:45] offset:1056

    v_mul_f32_e32 v208, v231, v195
    v_mul_f32_e32 v209, v230, v195
    v_fma_f32 v208, v230, v194, -v208
    v_fmac_f32_e32 v209, v231, v194
    v_cvt_pk_bf16_f32 v46, v208, v209
    v_lshlrev_b32 v50, 16, v46
    v_and_b32 v51, 0xffff0000, v46
    v_sub_f32_e32 v50, v208, v50
    v_sub_f32_e32 v51, v209, v51
    v_cvt_pk_bf16_f32 v47, v50, v51
    ds_write_b64 v2, v[46:47] offset:1584

    s_waitcnt lgkmcnt(4)
    v_mfma_f32_16x16x32_bf16 v[168:171], v[64:67], v[128:131], 0
    v_mfma_f32_16x16x32_bf16 v[172:175], v[96:99], v[128:131], 0
    v_mfma_f32_16x16x32_bf16 v[168:171], v[68:71], v[132:135], v[168:171]
    v_mfma_f32_16x16x32_bf16 v[172:175], v[100:103], v[132:135], v[172:175]
    v_mfma_f32_16x16x32_bf16 v[168:171], v[72:75], v[136:139], v[168:171]
    v_mfma_f32_16x16x32_bf16 v[172:175], v[104:107], v[136:139], v[172:175]
    v_mfma_f32_16x16x32_bf16 v[168:171], v[76:79], v[140:143], v[168:171]
    v_mfma_f32_16x16x32_bf16 v[172:175], v[108:111], v[140:143], v[172:175]
    v_mfma_f32_16x16x32_bf16 v[168:171], v[80:83], v[144:147], v[168:171]
    v_mfma_f32_16x16x32_bf16 v[172:175], v[112:115], v[144:147], v[172:175]
    v_mfma_f32_16x16x32_bf16 v[168:171], v[84:87], v[148:151], v[168:171]
    v_mfma_f32_16x16x32_bf16 v[172:175], v[116:119], v[148:151], v[172:175]
    v_mfma_f32_16x16x32_bf16 v[168:171], v[88:91], v[152:155], v[168:171]
    v_mfma_f32_16x16x32_bf16 v[172:175], v[120:123], v[152:155], v[172:175]
    v_mfma_f32_16x16x32_bf16 v[168:171], v[92:95], v[156:159], v[168:171]
    v_mfma_f32_16x16x32_bf16 v[172:175], v[124:127], v[156:159], v[172:175]
    v_cvt_pk_bf16_f32 v44, v232, v233
    v_lshlrev_b32 v48, 16, v44
    v_and_b32 v49, 0xffff0000, v44
    v_sub_f32_e32 v48, v232, v48
    v_sub_f32_e32 v49, v233, v49
    v_cvt_pk_bf16_f32 v45, v48, v49
    ds_write_b64 v2, v[44:45] offset:2112

    v_mul_f32_e32 v208, v233, v195
    v_mul_f32_e32 v209, v232, v195
    v_fma_f32 v208, v232, v194, -v208
    v_fmac_f32_e32 v209, v233, v194
    v_cvt_pk_bf16_f32 v46, v208, v209
    v_lshlrev_b32 v50, 16, v46
    v_and_b32 v51, 0xffff0000, v46
    v_sub_f32_e32 v50, v208, v50
    v_sub_f32_e32 v51, v209, v51
    v_cvt_pk_bf16_f32 v47, v50, v51
    ds_write_b64 v2, v[46:47] offset:2640

    v_cvt_pk_bf16_f32 v44, v234, v235
    v_lshlrev_b32 v48, 16, v44
    v_and_b32 v49, 0xffff0000, v44
    v_sub_f32_e32 v48, v234, v48
    v_sub_f32_e32 v49, v235, v49
    v_cvt_pk_bf16_f32 v45, v48, v49
    ds_write_b64 v2, v[44:45] offset:3168

    v_mul_f32_e32 v208, v235, v195
    v_mul_f32_e32 v209, v234, v195
    v_fma_f32 v208, v234, v194, -v208
    v_fmac_f32_e32 v209, v235, v194
    v_cvt_pk_bf16_f32 v46, v208, v209
    v_lshlrev_b32 v50, 16, v46
    v_and_b32 v51, 0xffff0000, v46
    v_sub_f32_e32 v50, v208, v50
    v_sub_f32_e32 v51, v209, v51
    v_cvt_pk_bf16_f32 v47, v50, v51
    ds_write_b64 v2, v[46:47] offset:3696

    v_cvt_pk_bf16_f32 v44, v236, v237
    v_lshlrev_b32 v48, 16, v44
    v_and_b32 v49, 0xffff0000, v44
    v_sub_f32_e32 v48, v236, v48
    v_sub_f32_e32 v49, v237, v49
    v_cvt_pk_bf16_f32 v45, v48, v49
    ds_write_b64 v2, v[44:45] offset:4224

    ds_read_b128 v[128:131], v3 offset:0
    ds_read_b128 v[132:135], v3 offset:64
    ds_read_b128 v[136:139], v3 offset:128
    ds_read_b128 v[140:143], v3 offset:192
    ds_read_b128 v[144:147], v3 offset:256
    ds_read_b128 v[148:151], v3 offset:320
    ds_read_b128 v[152:155], v3 offset:384
    ds_read_b128 v[156:159], v3 offset:448
    s_waitcnt vmcnt(0)
    v_lshlrev_b32 v1, 4, v15
    v_add_u32 v4, -8, v1
    s_lshl_b32 s12, s10, 1
    v_mov_b32 v8, s12
    s_mov_b32 s43, 0
    s_mov_b32 s44, 4096
    v_and_b32 v5, 31, v0
    v_lshrrev_b32 v6, 5, v0
    s_lshr_b32 s13, s3, 1
    s_lshl_b32 s13, s13, 11
    s_and_b32 s14, s3, 1
    s_lshl_b32 s14, s14, 5
    s_add_u32 s13, s13, s14
    v_lshlrev_b32 v13, 6, v5
    v_lshl_add_u32 v13, v6, 4, v13
    v_add_u32 v13, s13, v13

    buffer_load_dwordx4 v[184:187], v1, s[20:23], s43 offen
    buffer_load_dwordx2 v[188:189], v4, s[20:23], s43 offen

    buffer_load_dwordx4 v[200:203], v1, s[20:23], s44 offen
    buffer_load_dwordx2 v[204:205], v4, s[20:23], s44 offen

    buffer_load_ushort v190, v8, s[36:39], 0 offen offset:0
    buffer_load_dwordx4 v[192:195], v13, s[20:23], s43 offen

    buffer_load_ushort v206, v8, s[36:39], 0 offen offset:2
    buffer_load_dwordx4 v[208:211], v13, s[20:23], s44 offen

    s_waitcnt lgkmcnt(0)
    v_mfma_f32_16x16x32_bf16 v[176:179], v[64:67], v[128:131], 0
    v_mfma_f32_16x16x32_bf16 v[180:183], v[96:99], v[128:131], 0
    v_mfma_f32_16x16x32_bf16 v[176:179], v[68:71], v[132:135], v[176:179]
    v_mfma_f32_16x16x32_bf16 v[180:183], v[100:103], v[132:135], v[180:183]
    v_mfma_f32_16x16x32_bf16 v[176:179], v[72:75], v[136:139], v[176:179]
    v_mfma_f32_16x16x32_bf16 v[180:183], v[104:107], v[136:139], v[180:183]
    v_mfma_f32_16x16x32_bf16 v[176:179], v[76:79], v[140:143], v[176:179]
    v_mfma_f32_16x16x32_bf16 v[180:183], v[108:111], v[140:143], v[180:183]
    v_mfma_f32_16x16x32_bf16 v[176:179], v[80:83], v[144:147], v[176:179]
    v_mfma_f32_16x16x32_bf16 v[180:183], v[112:115], v[144:147], v[180:183]
    v_mfma_f32_16x16x32_bf16 v[176:179], v[84:87], v[148:151], v[176:179]
    v_mfma_f32_16x16x32_bf16 v[180:183], v[116:119], v[148:151], v[180:183]
    v_mfma_f32_16x16x32_bf16 v[176:179], v[88:91], v[152:155], v[176:179]
    v_mfma_f32_16x16x32_bf16 v[180:183], v[120:123], v[152:155], v[180:183]
    v_mfma_f32_16x16x32_bf16 v[176:179], v[92:95], v[156:159], v[176:179]
    v_mfma_f32_16x16x32_bf16 v[180:183], v[124:127], v[156:159], v[180:183]
    s_setprio 3
    v_mov_b32 v40, 0
    v_mov_b32 v41, 0
    v_mov_b32 v42, 0
    v_mov_b32 v43, 0
    v_cmp_gt_u32 vcc, 160, v15
    s_and_saveexec_b64 s[40:41], vcc
    ds_write_b128 v1, v[40:43] offset:0
    ds_write_b128 v1, v[40:43] offset:7680
    ds_write_b128 v1, v[40:43] offset:32768
    ds_write_b128 v1, v[40:43] offset:40448
    s_mov_b64 exec, s[40:41]
    s_nop 3

    v_add_f32 v160, v160, v164
    ds_write_b32 v60, v160 offset:0
    v_add_f32 v161, v161, v165
    ds_write_b32 v60, v161 offset:208
    v_add_f32 v162, v162, v166
    ds_write_b32 v60, v162 offset:416
    v_add_f32 v163, v163, v167
    ds_write_b32 v60, v163 offset:624
    v_add_f32 v168, v168, v172
    ds_write_b32 v60, v168 offset:64
    v_add_f32 v169, v169, v173
    ds_write_b32 v60, v169 offset:272
    v_add_f32 v170, v170, v174
    ds_write_b32 v60, v170 offset:480
    v_add_f32 v171, v171, v175
    ds_write_b32 v60, v171 offset:688
    v_add_f32 v176, v176, v180
    ds_write_b32 v60, v176 offset:128
    v_add_f32 v177, v177, v181
    ds_write_b32 v60, v177 offset:336
    v_add_f32 v178, v178, v182
    ds_write_b32 v60, v178 offset:544
    v_add_f32 v179, v179, v183
    ds_write_b32 v60, v179 offset:752
    v_lshrrev_b32 v7, 2, v15
    v_mul_u32_u24 v7, 80, v7
    v_and_b32 v12, 3, v15
    v_lshl_add_u32 v7, v12, 4, v7
    v_lshrrev_b32 v9, 2, v15
    v_mul_u32_u24 v9, 4160, v9
    v_lshl_add_u32 v9, v12, 4, v9
    v_sub_u32 v12, 255, v15
    v_lshlrev_b32 v12, 4, v12
    s_mov_b32 s42, 0xffff
    v_sub_u32 v3, 3, v5
    v_and_b32 v3, 3, v3
    v_mul_u32_u24 v1, 4160, v3
    v_add_u32 v3, v3, v5
    v_lshlrev_b32 v3, 1, v3
    v_sub_u32 v1, v1, v3
    v_lshl_add_u32 v1, v6, 4, v1
    s_lshl_b32 s14, s3, 6
    s_sub_u32 s15, 15614, s14
    v_add_u32 v1, s15, v1
    v_mul_u32_u24 v2, 80, v5
    v_lshl_add_u32 v2, v6, 4, v2
    s_sub_u32 s14, 3, s3
    s_mul_i32 s14, s14, 80
    v_add_u32 v2, s14, v2
    s_waitcnt lgkmcnt(0)
    s_barrier

    s_cmp_lg_u32 s3, 0
    s_cbranch_scc1 Lc_nf

    s_add_u32 s24, s16, 0x1400000
    s_addc_u32 s25, s17, 0
    s_and_b32 s25, s25, 0xffff
    s_mov_b32 s26, 0x18000
    s_mov_b32 s27, 0x20000
    s_lshr_b32 s14, s2, 5
    s_lshl_b32 s14, s14, 8
    s_and_b32 s15, s2, 31
    s_lshl_b32 s15, s15, 2
    s_add_u32 s14, s14, s15
    s_add_u32 s14, s14, 65536
    v_mov_b32 v248, 1
    v_mov_b32 v249, 0
    s_mov_b64 exec, 1
    buffer_store_dword v248, v249, s[24:27], s14 offen sc1
    s_mov_b64 exec, -1
Lc_nf:

    ds_read2st64_b32 v[64:65], v52 offset0:60 offset1:93
    ds_read2st64_b32 v[66:67], v53 offset0:60 offset1:93
    ds_read2st64_b32 v[68:69], v54 offset0:60 offset1:93
    ds_read2st64_b32 v[70:71], v55 offset0:60 offset1:93
    ds_read2st64_b32 v[72:73], v56 offset0:60 offset1:93
    ds_read2st64_b32 v[74:75], v57 offset0:60 offset1:93
    ds_read2st64_b32 v[76:77], v58 offset0:60 offset1:93
    ds_read2st64_b32 v[78:79], v59 offset0:60 offset1:93
    ds_read2st64_b32 v[80:81], v52 offset0:188 offset1:221
    ds_read2st64_b32 v[82:83], v53 offset0:188 offset1:221
    ds_read2st64_b32 v[84:85], v54 offset0:188 offset1:221
    ds_read2st64_b32 v[86:87], v55 offset0:188 offset1:221
    ds_read2st64_b32 v[88:89], v56 offset0:188 offset1:221
    ds_read2st64_b32 v[90:91], v57 offset0:188 offset1:221
    ds_read2st64_b32 v[92:93], v58 offset0:188 offset1:221
    ds_read2st64_b32 v[94:95], v59 offset0:188 offset1:221
    s_waitcnt lgkmcnt(8)
    v_add_f32 v64, v64, v65
    v_add_f32 v66, v66, v67
    v_add_f32 v68, v68, v69
    v_add_f32 v70, v70, v71
    v_add_f32 v72, v72, v73
    v_add_f32 v74, v74, v75
    v_add_f32 v76, v76, v77
    v_add_f32 v78, v78, v79
    v_cvt_pk_bf16_f32 v32, v64, v66
    v_lshlrev_b32 v20, 16, v32
    v_and_b32 v21, 0xffff0000, v32
    v_sub_f32 v20, v64, v20
    v_sub_f32 v21, v66, v21
    v_cvt_pk_bf16_f32 v36, v20, v21

    v_cvt_pk_bf16_f32 v33, v68, v70
    v_lshlrev_b32 v20, 16, v33
    v_and_b32 v21, 0xffff0000, v33
    v_sub_f32 v20, v68, v20
    v_sub_f32 v21, v70, v21
    v_cvt_pk_bf16_f32 v37, v20, v21

    v_cvt_pk_bf16_f32 v34, v72, v74
    v_lshlrev_b32 v20, 16, v34
    v_and_b32 v21, 0xffff0000, v34
    v_sub_f32 v20, v72, v20
    v_sub_f32 v21, v74, v21
    v_cvt_pk_bf16_f32 v38, v20, v21

    v_cvt_pk_bf16_f32 v35, v76, v78
    v_lshlrev_b32 v20, 16, v35
    v_and_b32 v21, 0xffff0000, v35
    v_sub_f32 v20, v76, v20
    v_sub_f32 v21, v78, v21
    v_cvt_pk_bf16_f32 v39, v20, v21

    ds_write_b128 v7, v[32:35] offset:2560
    ds_write_b128 v7, v[36:39] offset:10240
    s_waitcnt lgkmcnt(0)
    v_add_f32 v80, v80, v81
    v_add_f32 v82, v82, v83
    v_add_f32 v84, v84, v85
    v_add_f32 v86, v86, v87
    v_add_f32 v88, v88, v89
    v_add_f32 v90, v90, v91
    v_add_f32 v92, v92, v93
    v_add_f32 v94, v94, v95
    s_barrier
    v_cvt_pk_bf16_f32 v40, v80, v82
    v_lshlrev_b32 v20, 16, v40
    v_and_b32 v21, 0xffff0000, v40
    v_sub_f32 v20, v80, v20
    v_sub_f32 v21, v82, v21
    v_cvt_pk_bf16_f32 v44, v20, v21

    v_cvt_pk_bf16_f32 v41, v84, v86
    v_lshlrev_b32 v20, 16, v41
    v_and_b32 v21, 0xffff0000, v41
    v_sub_f32 v20, v84, v20
    v_sub_f32 v21, v86, v21
    v_cvt_pk_bf16_f32 v45, v20, v21

    v_cvt_pk_bf16_f32 v42, v88, v90
    v_lshlrev_b32 v20, 16, v42
    v_and_b32 v21, 0xffff0000, v42
    v_sub_f32 v20, v88, v20
    v_sub_f32 v21, v90, v21
    v_cvt_pk_bf16_f32 v46, v20, v21

    v_cvt_pk_bf16_f32 v43, v92, v94
    v_lshlrev_b32 v20, 16, v43
    v_and_b32 v21, 0xffff0000, v43
    v_sub_f32 v20, v92, v20
    v_sub_f32 v21, v94, v21
    v_cvt_pk_bf16_f32 v47, v20, v21

    ds_write_b128 v7, v[40:43] offset:35328
    ds_write_b128 v7, v[44:47] offset:43008
    v_mov_b32 v16, 0
    v_mov_b32 v17, 0
    v_mov_b32 v18, 0
    v_mov_b32 v19, 0
    v_cmp_gt_u32 vcc, 16, v15
    s_and_saveexec_b64 s[40:41], vcc
    ds_write_b128 v9, v[16:19] offset:19456
    ds_write_b128 v9, v[16:19] offset:52224
    s_mov_b64 exec, s[40:41]
    v_cmp_eq_u32 vcc, 0, v15

    s_waitcnt vmcnt(6)
    v_alignbit_b32 v96, v187, v187, 16
    v_alignbit_b32 v97, v186, v186, 16
    v_alignbit_b32 v98, v185, v185, 16
    v_alignbit_b32 v99, v184, v184, 16
    ds_write_b128 v12, v[96:99] offset:15360
    v_bfi_b32 v100, s42, v187, v186
    v_bfi_b32 v101, s42, v186, v185
    v_bfi_b32 v102, s42, v185, v184
    v_bfi_b32 v103, s42, v184, v189
    ds_write_b128 v12, v[100:103] offset:19520
    v_alignbit_b32 v104, v186, v186, 16
    v_alignbit_b32 v105, v185, v185, 16
    v_alignbit_b32 v106, v184, v184, 16
    v_alignbit_b32 v107, v189, v189, 16
    ds_write_b128 v12, v[104:107] offset:23680
    v_bfi_b32 v108, s42, v186, v185
    v_bfi_b32 v109, s42, v185, v184
    v_bfi_b32 v110, s42, v184, v189
    v_bfi_b32 v111, s42, v189, v188
    ds_write_b128 v12, v[108:111] offset:27840
    s_waitcnt vmcnt(4)
    v_cndmask_b32_e64 v204, v204, 0, vcc
    v_cndmask_b32_e64 v205, v205, 0, vcc
    v_alignbit_b32 v112, v203, v203, 16
    v_alignbit_b32 v113, v202, v202, 16
    v_alignbit_b32 v114, v201, v201, 16
    v_alignbit_b32 v115, v200, v200, 16
    ds_write_b128 v12, v[112:115] offset:48128
    v_bfi_b32 v116, s42, v203, v202
    v_bfi_b32 v117, s42, v202, v201
    v_bfi_b32 v118, s42, v201, v200
    v_bfi_b32 v119, s42, v200, v205
    ds_write_b128 v12, v[116:119] offset:52288
    v_alignbit_b32 v120, v202, v202, 16
    v_alignbit_b32 v121, v201, v201, 16
    v_alignbit_b32 v122, v200, v200, 16
    v_alignbit_b32 v123, v205, v205, 16
    ds_write_b128 v12, v[120:123] offset:56448
    v_bfi_b32 v124, s42, v202, v201
    v_bfi_b32 v125, s42, v201, v200
    v_bfi_b32 v126, s42, v200, v205
    v_bfi_b32 v127, s42, v205, v204
    ds_write_b128 v12, v[124:127] offset:60608
    s_waitcnt lgkmcnt(0)
    s_barrier
    s_setprio 1
    ds_read_b64 v[16:17], v1 offset:3840
    ds_read_b64 v[18:19], v1 offset:3848
    ds_read_b128 v[24:27], v2 offset:2320
    ds_read_b128 v[28:31], v2 offset:10000
    ds_read_b64 v[20:21], v1 offset:1792
    ds_read_b64 v[22:23], v1 offset:1800
    ds_read_b128 v[32:35], v2 offset:4880
    ds_read_b128 v[36:39], v2 offset:12560
    ds_read_b64 v[40:41], v1 offset:3872
    ds_read_b64 v[42:43], v1 offset:3880
    ds_read_b128 v[48:51], v2 offset:2352
    ds_read_b128 v[52:55], v2 offset:10032
    ds_read_b64 v[44:45], v1 offset:1824
    ds_read_b64 v[46:47], v1 offset:1832
    ds_read_b128 v[56:59], v2 offset:4912
    ds_read_b128 v[60:63], v2 offset:12592
    s_waitcnt lgkmcnt(8)
    v_mfma_f32_32x32x16_bf16 v[64:79], v[16:19], v[24:27], 0
    v_mfma_f32_32x32x16_bf16 v[80:95], v[20:23], v[24:27], 0
    v_mfma_f32_32x32x16_bf16 v[64:79], v[16:19], v[28:31], v[64:79]
    v_mfma_f32_32x32x16_bf16 v[80:95], v[16:19], v[32:35], v[80:95]
    v_mfma_f32_32x32x16_bf16 v[80:95], v[20:23], v[28:31], v[80:95]
    v_mfma_f32_32x32x16_bf16 v[80:95], v[16:19], v[36:39], v[80:95]
    ds_read_b64 v[16:17], v1 offset:3584
    ds_read_b64 v[18:19], v1 offset:3592
    ds_read_b128 v[24:27], v2 offset:2000
    ds_read_b128 v[28:31], v2 offset:9680
    ds_read_b64 v[20:21], v1 offset:1536
    ds_read_b64 v[22:23], v1 offset:1544
    ds_read_b128 v[32:35], v2 offset:4560
    ds_read_b128 v[36:39], v2 offset:12240
    s_waitcnt lgkmcnt(8)
    v_mfma_f32_32x32x16_bf16 v[64:79], v[40:43], v[48:51], v[64:79]
    v_mfma_f32_32x32x16_bf16 v[80:95], v[44:47], v[48:51], v[80:95]
    v_mfma_f32_32x32x16_bf16 v[64:79], v[40:43], v[52:55], v[64:79]
    v_mfma_f32_32x32x16_bf16 v[80:95], v[40:43], v[56:59], v[80:95]
    v_mfma_f32_32x32x16_bf16 v[80:95], v[44:47], v[52:55], v[80:95]
    v_mfma_f32_32x32x16_bf16 v[80:95], v[40:43], v[60:63], v[80:95]
    ds_read_b64 v[40:41], v1 offset:3616
    ds_read_b64 v[42:43], v1 offset:3624
    ds_read_b128 v[48:51], v2 offset:2032
    ds_read_b128 v[52:55], v2 offset:9712
    ds_read_b64 v[44:45], v1 offset:1568
    ds_read_b64 v[46:47], v1 offset:1576
    ds_read_b128 v[56:59], v2 offset:4592
    ds_read_b128 v[60:63], v2 offset:12272
    s_waitcnt lgkmcnt(8)
    v_mfma_f32_32x32x16_bf16 v[64:79], v[16:19], v[24:27], v[64:79]
    v_mfma_f32_32x32x16_bf16 v[80:95], v[20:23], v[24:27], v[80:95]
    v_mfma_f32_32x32x16_bf16 v[64:79], v[16:19], v[28:31], v[64:79]
    v_mfma_f32_32x32x16_bf16 v[80:95], v[16:19], v[32:35], v[80:95]
    v_mfma_f32_32x32x16_bf16 v[80:95], v[20:23], v[28:31], v[80:95]
    v_mfma_f32_32x32x16_bf16 v[80:95], v[16:19], v[36:39], v[80:95]
    ds_read_b64 v[16:17], v1 offset:3328
    ds_read_b64 v[18:19], v1 offset:3336
    ds_read_b128 v[24:27], v2 offset:1680
    ds_read_b128 v[28:31], v2 offset:9360
    ds_read_b64 v[20:21], v1 offset:1280
    ds_read_b64 v[22:23], v1 offset:1288
    ds_read_b128 v[32:35], v2 offset:4240
    ds_read_b128 v[36:39], v2 offset:11920
    s_waitcnt lgkmcnt(8)
    v_mfma_f32_32x32x16_bf16 v[64:79], v[40:43], v[48:51], v[64:79]
    v_mfma_f32_32x32x16_bf16 v[80:95], v[44:47], v[48:51], v[80:95]
    v_mfma_f32_32x32x16_bf16 v[64:79], v[40:43], v[52:55], v[64:79]
    v_mfma_f32_32x32x16_bf16 v[80:95], v[40:43], v[56:59], v[80:95]
    v_mfma_f32_32x32x16_bf16 v[80:95], v[44:47], v[52:55], v[80:95]
    v_mfma_f32_32x32x16_bf16 v[80:95], v[40:43], v[60:63], v[80:95]
    ds_read_b64 v[40:41], v1 offset:3360
    ds_read_b64 v[42:43], v1 offset:3368
    ds_read_b128 v[48:51], v2 offset:1712
    ds_read_b128 v[52:55], v2 offset:9392
    ds_read_b64 v[44:45], v1 offset:1312
    ds_read_b64 v[46:47], v1 offset:1320
    ds_read_b128 v[56:59], v2 offset:4272
    ds_read_b128 v[60:63], v2 offset:11952
    s_waitcnt lgkmcnt(8)
    v_mfma_f32_32x32x16_bf16 v[64:79], v[16:19], v[24:27], v[64:79]
    v_mfma_f32_32x32x16_bf16 v[80:95], v[20:23], v[24:27], v[80:95]
    v_mfma_f32_32x32x16_bf16 v[64:79], v[16:19], v[28:31], v[64:79]
    v_mfma_f32_32x32x16_bf16 v[80:95], v[16:19], v[32:35], v[80:95]
    v_mfma_f32_32x32x16_bf16 v[80:95], v[20:23], v[28:31], v[80:95]
    v_mfma_f32_32x32x16_bf16 v[80:95], v[16:19], v[36:39], v[80:95]
    ds_read_b64 v[16:17], v1 offset:3072
    ds_read_b64 v[18:19], v1 offset:3080
    ds_read_b128 v[24:27], v2 offset:1360
    ds_read_b128 v[28:31], v2 offset:9040
    ds_read_b64 v[20:21], v1 offset:1024
    ds_read_b64 v[22:23], v1 offset:1032
    ds_read_b128 v[32:35], v2 offset:3920
    ds_read_b128 v[36:39], v2 offset:11600
    s_waitcnt lgkmcnt(8)
    v_mfma_f32_32x32x16_bf16 v[64:79], v[40:43], v[48:51], v[64:79]
    v_mfma_f32_32x32x16_bf16 v[80:95], v[44:47], v[48:51], v[80:95]
    v_mfma_f32_32x32x16_bf16 v[64:79], v[40:43], v[52:55], v[64:79]
    v_mfma_f32_32x32x16_bf16 v[80:95], v[40:43], v[56:59], v[80:95]
    v_mfma_f32_32x32x16_bf16 v[80:95], v[44:47], v[52:55], v[80:95]
    v_mfma_f32_32x32x16_bf16 v[80:95], v[40:43], v[60:63], v[80:95]
    ds_read_b64 v[40:41], v1 offset:3104
    ds_read_b64 v[42:43], v1 offset:3112
    ds_read_b128 v[48:51], v2 offset:1392
    ds_read_b128 v[52:55], v2 offset:9072
    ds_read_b64 v[44:45], v1 offset:1056
    ds_read_b64 v[46:47], v1 offset:1064
    ds_read_b128 v[56:59], v2 offset:3952
    ds_read_b128 v[60:63], v2 offset:11632
    s_waitcnt lgkmcnt(8)
    v_mfma_f32_32x32x16_bf16 v[64:79], v[16:19], v[24:27], v[64:79]
    v_mfma_f32_32x32x16_bf16 v[80:95], v[20:23], v[24:27], v[80:95]
    v_mfma_f32_32x32x16_bf16 v[64:79], v[16:19], v[28:31], v[64:79]
    v_mfma_f32_32x32x16_bf16 v[80:95], v[16:19], v[32:35], v[80:95]
    v_mfma_f32_32x32x16_bf16 v[80:95], v[20:23], v[28:31], v[80:95]
    v_mfma_f32_32x32x16_bf16 v[80:95], v[16:19], v[36:39], v[80:95]
    ds_read_b64 v[16:17], v1 offset:2816
    ds_read_b64 v[18:19], v1 offset:2824
    ds_read_b128 v[24:27], v2 offset:1040
    ds_read_b128 v[28:31], v2 offset:8720
    ds_read_b64 v[20:21], v1 offset:768
    ds_read_b64 v[22:23], v1 offset:776
    ds_read_b128 v[32:35], v2 offset:3600
    ds_read_b128 v[36:39], v2 offset:11280
    s_waitcnt lgkmcnt(8)
    v_mfma_f32_32x32x16_bf16 v[64:79], v[40:43], v[48:51], v[64:79]
    v_mfma_f32_32x32x16_bf16 v[80:95], v[44:47], v[48:51], v[80:95]
    v_mfma_f32_32x32x16_bf16 v[64:79], v[40:43], v[52:55], v[64:79]
    v_mfma_f32_32x32x16_bf16 v[80:95], v[40:43], v[56:59], v[80:95]
    v_mfma_f32_32x32x16_bf16 v[80:95], v[44:47], v[52:55], v[80:95]
    v_mfma_f32_32x32x16_bf16 v[80:95], v[40:43], v[60:63], v[80:95]
    ds_read_b64 v[40:41], v1 offset:2848
    ds_read_b64 v[42:43], v1 offset:2856
    ds_read_b128 v[48:51], v2 offset:1072
    ds_read_b128 v[52:55], v2 offset:8752
    ds_read_b64 v[44:45], v1 offset:800
    ds_read_b64 v[46:47], v1 offset:808
    ds_read_b128 v[56:59], v2 offset:3632
    ds_read_b128 v[60:63], v2 offset:11312
    s_waitcnt lgkmcnt(8)
    v_mfma_f32_32x32x16_bf16 v[64:79], v[16:19], v[24:27], v[64:79]
    v_mfma_f32_32x32x16_bf16 v[80:95], v[20:23], v[24:27], v[80:95]
    v_mfma_f32_32x32x16_bf16 v[64:79], v[16:19], v[28:31], v[64:79]
    v_mfma_f32_32x32x16_bf16 v[80:95], v[16:19], v[32:35], v[80:95]
    v_mfma_f32_32x32x16_bf16 v[80:95], v[20:23], v[28:31], v[80:95]
    v_mfma_f32_32x32x16_bf16 v[80:95], v[16:19], v[36:39], v[80:95]
    ds_read_b64 v[16:17], v1 offset:2560
    ds_read_b64 v[18:19], v1 offset:2568
    ds_read_b128 v[24:27], v2 offset:720
    ds_read_b128 v[28:31], v2 offset:8400
    ds_read_b64 v[20:21], v1 offset:512
    ds_read_b64 v[22:23], v1 offset:520
    ds_read_b128 v[32:35], v2 offset:3280
    ds_read_b128 v[36:39], v2 offset:10960
    s_waitcnt lgkmcnt(8)
    v_mfma_f32_32x32x16_bf16 v[64:79], v[40:43], v[48:51], v[64:79]
    v_mfma_f32_32x32x16_bf16 v[80:95], v[44:47], v[48:51], v[80:95]
    v_mfma_f32_32x32x16_bf16 v[64:79], v[40:43], v[52:55], v[64:79]
    v_mfma_f32_32x32x16_bf16 v[80:95], v[40:43], v[56:59], v[80:95]
    v_mfma_f32_32x32x16_bf16 v[80:95], v[44:47], v[52:55], v[80:95]
    v_mfma_f32_32x32x16_bf16 v[80:95], v[40:43], v[60:63], v[80:95]
    ds_read_b64 v[40:41], v1 offset:2592
    ds_read_b64 v[42:43], v1 offset:2600
    ds_read_b128 v[48:51], v2 offset:752
    ds_read_b128 v[52:55], v2 offset:8432
    ds_read_b64 v[44:45], v1 offset:544
    ds_read_b64 v[46:47], v1 offset:552
    ds_read_b128 v[56:59], v2 offset:3312
    ds_read_b128 v[60:63], v2 offset:10992
    s_waitcnt lgkmcnt(8)
    v_mfma_f32_32x32x16_bf16 v[64:79], v[16:19], v[24:27], v[64:79]
    v_mfma_f32_32x32x16_bf16 v[80:95], v[20:23], v[24:27], v[80:95]
    v_mfma_f32_32x32x16_bf16 v[64:79], v[16:19], v[28:31], v[64:79]
    v_mfma_f32_32x32x16_bf16 v[80:95], v[16:19], v[32:35], v[80:95]
    v_mfma_f32_32x32x16_bf16 v[80:95], v[20:23], v[28:31], v[80:95]
    v_mfma_f32_32x32x16_bf16 v[80:95], v[16:19], v[36:39], v[80:95]
    ds_read_b64 v[16:17], v1 offset:2304
    ds_read_b64 v[18:19], v1 offset:2312
    ds_read_b128 v[24:27], v2 offset:400
    ds_read_b128 v[28:31], v2 offset:8080
    ds_read_b64 v[20:21], v1 offset:256
    ds_read_b64 v[22:23], v1 offset:264
    ds_read_b128 v[32:35], v2 offset:2960
    ds_read_b128 v[36:39], v2 offset:10640
    s_waitcnt lgkmcnt(8)
    v_mfma_f32_32x32x16_bf16 v[64:79], v[40:43], v[48:51], v[64:79]
    v_mfma_f32_32x32x16_bf16 v[80:95], v[44:47], v[48:51], v[80:95]
    v_mfma_f32_32x32x16_bf16 v[64:79], v[40:43], v[52:55], v[64:79]
    v_mfma_f32_32x32x16_bf16 v[80:95], v[40:43], v[56:59], v[80:95]
    v_mfma_f32_32x32x16_bf16 v[80:95], v[44:47], v[52:55], v[80:95]
    v_mfma_f32_32x32x16_bf16 v[80:95], v[40:43], v[60:63], v[80:95]
    ds_read_b64 v[40:41], v1 offset:2336
    ds_read_b64 v[42:43], v1 offset:2344
    ds_read_b128 v[48:51], v2 offset:432
    ds_read_b128 v[52:55], v2 offset:8112
    ds_read_b64 v[44:45], v1 offset:288
    ds_read_b64 v[46:47], v1 offset:296
    ds_read_b128 v[56:59], v2 offset:2992
    ds_read_b128 v[60:63], v2 offset:10672
    s_waitcnt lgkmcnt(8)
    v_mfma_f32_32x32x16_bf16 v[64:79], v[16:19], v[24:27], v[64:79]
    v_mfma_f32_32x32x16_bf16 v[80:95], v[20:23], v[24:27], v[80:95]
    v_mfma_f32_32x32x16_bf16 v[64:79], v[16:19], v[28:31], v[64:79]
    v_mfma_f32_32x32x16_bf16 v[80:95], v[16:19], v[32:35], v[80:95]
    v_mfma_f32_32x32x16_bf16 v[80:95], v[20:23], v[28:31], v[80:95]
    v_mfma_f32_32x32x16_bf16 v[80:95], v[16:19], v[36:39], v[80:95]
    ds_read_b64 v[16:17], v1 offset:2048
    ds_read_b64 v[18:19], v1 offset:2056
    ds_read_b128 v[24:27], v2 offset:80
    ds_read_b128 v[28:31], v2 offset:7760
    ds_read_b64 v[20:21], v1 offset:0
    ds_read_b64 v[22:23], v1 offset:8
    ds_read_b128 v[32:35], v2 offset:2640
    ds_read_b128 v[36:39], v2 offset:10320
    s_waitcnt lgkmcnt(8)
    v_mfma_f32_32x32x16_bf16 v[64:79], v[40:43], v[48:51], v[64:79]
    v_mfma_f32_32x32x16_bf16 v[80:95], v[44:47], v[48:51], v[80:95]
    v_mfma_f32_32x32x16_bf16 v[64:79], v[40:43], v[52:55], v[64:79]
    v_mfma_f32_32x32x16_bf16 v[80:95], v[40:43], v[56:59], v[80:95]
    v_mfma_f32_32x32x16_bf16 v[80:95], v[44:47], v[52:55], v[80:95]
    v_mfma_f32_32x32x16_bf16 v[80:95], v[40:43], v[60:63], v[80:95]
    ds_read_b64 v[40:41], v1 offset:2080
    ds_read_b64 v[42:43], v1 offset:2088
    ds_read_b128 v[48:51], v2 offset:112
    ds_read_b128 v[52:55], v2 offset:7792
    ds_read_b64 v[44:45], v1 offset:32
    ds_read_b64 v[46:47], v1 offset:40
    ds_read_b128 v[56:59], v2 offset:2672
    ds_read_b128 v[60:63], v2 offset:10352
    s_waitcnt lgkmcnt(8)
    v_mfma_f32_32x32x16_bf16 v[64:79], v[16:19], v[24:27], v[64:79]
    v_mfma_f32_32x32x16_bf16 v[80:95], v[20:23], v[24:27], v[80:95]
    v_mfma_f32_32x32x16_bf16 v[64:79], v[16:19], v[28:31], v[64:79]
    v_mfma_f32_32x32x16_bf16 v[80:95], v[16:19], v[32:35], v[80:95]
    v_mfma_f32_32x32x16_bf16 v[80:95], v[20:23], v[28:31], v[80:95]
    v_mfma_f32_32x32x16_bf16 v[80:95], v[16:19], v[36:39], v[80:95]
    ds_read_b64 v[16:17], v1 offset:36608
    ds_read_b64 v[18:19], v1 offset:36616
    ds_read_b128 v[24:27], v2 offset:35088
    ds_read_b128 v[28:31], v2 offset:42768
    ds_read_b64 v[20:21], v1 offset:34560
    ds_read_b64 v[22:23], v1 offset:34568
    ds_read_b128 v[32:35], v2 offset:37648
    ds_read_b128 v[36:39], v2 offset:45328
    s_waitcnt lgkmcnt(8)
    v_mfma_f32_32x32x16_bf16 v[64:79], v[40:43], v[48:51], v[64:79]
    v_mfma_f32_32x32x16_bf16 v[80:95], v[44:47], v[48:51], v[80:95]
    v_mfma_f32_32x32x16_bf16 v[64:79], v[40:43], v[52:55], v[64:79]
    v_mfma_f32_32x32x16_bf16 v[80:95], v[40:43], v[56:59], v[80:95]
    v_mfma_f32_32x32x16_bf16 v[80:95], v[44:47], v[52:55], v[80:95]
    v_mfma_f32_32x32x16_bf16 v[80:95], v[40:43], v[60:63], v[80:95]
    ds_read_b64 v[40:41], v1 offset:36640
    ds_read_b64 v[42:43], v1 offset:36648
    ds_read_b128 v[48:51], v2 offset:35120
    ds_read_b128 v[52:55], v2 offset:42800
    ds_read_b64 v[44:45], v1 offset:34592
    ds_read_b64 v[46:47], v1 offset:34600
    ds_read_b128 v[56:59], v2 offset:37680
    ds_read_b128 v[60:63], v2 offset:45360
    s_waitcnt lgkmcnt(8)
    v_mfma_f32_32x32x16_bf16 v[96:111], v[16:19], v[24:27], 0
    v_mfma_f32_32x32x16_bf16 v[112:127], v[20:23], v[24:27], 0
    v_mfma_f32_32x32x16_bf16 v[96:111], v[16:19], v[28:31], v[96:111]
    v_mfma_f32_32x32x16_bf16 v[112:127], v[16:19], v[32:35], v[112:127]
    v_mfma_f32_32x32x16_bf16 v[112:127], v[20:23], v[28:31], v[112:127]
    v_mfma_f32_32x32x16_bf16 v[112:127], v[16:19], v[36:39], v[112:127]
    ds_read_b64 v[16:17], v1 offset:36352
    ds_read_b64 v[18:19], v1 offset:36360
    ds_read_b128 v[24:27], v2 offset:34768
    ds_read_b128 v[28:31], v2 offset:42448
    ds_read_b64 v[20:21], v1 offset:34304
    ds_read_b64 v[22:23], v1 offset:34312
    ds_read_b128 v[32:35], v2 offset:37328
    ds_read_b128 v[36:39], v2 offset:45008
    s_waitcnt lgkmcnt(8)
    v_mfma_f32_32x32x16_bf16 v[96:111], v[40:43], v[48:51], v[96:111]
    v_mfma_f32_32x32x16_bf16 v[112:127], v[44:47], v[48:51], v[112:127]
    v_mfma_f32_32x32x16_bf16 v[96:111], v[40:43], v[52:55], v[96:111]
    v_mfma_f32_32x32x16_bf16 v[112:127], v[40:43], v[56:59], v[112:127]
    v_mfma_f32_32x32x16_bf16 v[112:127], v[44:47], v[52:55], v[112:127]
    v_mfma_f32_32x32x16_bf16 v[112:127], v[40:43], v[60:63], v[112:127]
    ds_read_b64 v[40:41], v1 offset:36384
    ds_read_b64 v[42:43], v1 offset:36392
    ds_read_b128 v[48:51], v2 offset:34800
    ds_read_b128 v[52:55], v2 offset:42480
    ds_read_b64 v[44:45], v1 offset:34336
    ds_read_b64 v[46:47], v1 offset:34344
    ds_read_b128 v[56:59], v2 offset:37360
    ds_read_b128 v[60:63], v2 offset:45040
    s_waitcnt lgkmcnt(8)
    v_mfma_f32_32x32x16_bf16 v[96:111], v[16:19], v[24:27], v[96:111]
    v_mfma_f32_32x32x16_bf16 v[112:127], v[20:23], v[24:27], v[112:127]
    v_mfma_f32_32x32x16_bf16 v[96:111], v[16:19], v[28:31], v[96:111]
    v_mfma_f32_32x32x16_bf16 v[112:127], v[16:19], v[32:35], v[112:127]
    v_mfma_f32_32x32x16_bf16 v[112:127], v[20:23], v[28:31], v[112:127]
    v_mfma_f32_32x32x16_bf16 v[112:127], v[16:19], v[36:39], v[112:127]
    ds_read_b64 v[16:17], v1 offset:36096
    ds_read_b64 v[18:19], v1 offset:36104
    ds_read_b128 v[24:27], v2 offset:34448
    ds_read_b128 v[28:31], v2 offset:42128
    ds_read_b64 v[20:21], v1 offset:34048
    ds_read_b64 v[22:23], v1 offset:34056
    ds_read_b128 v[32:35], v2 offset:37008
    ds_read_b128 v[36:39], v2 offset:44688
    s_waitcnt lgkmcnt(8)
    v_mfma_f32_32x32x16_bf16 v[96:111], v[40:43], v[48:51], v[96:111]
    v_mfma_f32_32x32x16_bf16 v[112:127], v[44:47], v[48:51], v[112:127]
    v_mfma_f32_32x32x16_bf16 v[96:111], v[40:43], v[52:55], v[96:111]
    v_mfma_f32_32x32x16_bf16 v[112:127], v[40:43], v[56:59], v[112:127]
    v_mfma_f32_32x32x16_bf16 v[112:127], v[44:47], v[52:55], v[112:127]
    v_mfma_f32_32x32x16_bf16 v[112:127], v[40:43], v[60:63], v[112:127]
    ds_read_b64 v[40:41], v1 offset:36128
    ds_read_b64 v[42:43], v1 offset:36136
    ds_read_b128 v[48:51], v2 offset:34480
    ds_read_b128 v[52:55], v2 offset:42160
    ds_read_b64 v[44:45], v1 offset:34080
    ds_read_b64 v[46:47], v1 offset:34088
    ds_read_b128 v[56:59], v2 offset:37040
    ds_read_b128 v[60:63], v2 offset:44720
    s_waitcnt lgkmcnt(8)
    v_mfma_f32_32x32x16_bf16 v[96:111], v[16:19], v[24:27], v[96:111]
    v_mfma_f32_32x32x16_bf16 v[112:127], v[20:23], v[24:27], v[112:127]
    v_mfma_f32_32x32x16_bf16 v[96:111], v[16:19], v[28:31], v[96:111]
    v_mfma_f32_32x32x16_bf16 v[112:127], v[16:19], v[32:35], v[112:127]
    v_mfma_f32_32x32x16_bf16 v[112:127], v[20:23], v[28:31], v[112:127]
    v_mfma_f32_32x32x16_bf16 v[112:127], v[16:19], v[36:39], v[112:127]
    ds_read_b64 v[16:17], v1 offset:35840
    ds_read_b64 v[18:19], v1 offset:35848
    ds_read_b128 v[24:27], v2 offset:34128
    ds_read_b128 v[28:31], v2 offset:41808
    ds_read_b64 v[20:21], v1 offset:33792
    ds_read_b64 v[22:23], v1 offset:33800
    ds_read_b128 v[32:35], v2 offset:36688
    ds_read_b128 v[36:39], v2 offset:44368
    s_waitcnt lgkmcnt(8)
    v_mfma_f32_32x32x16_bf16 v[96:111], v[40:43], v[48:51], v[96:111]
    v_mfma_f32_32x32x16_bf16 v[112:127], v[44:47], v[48:51], v[112:127]
    v_mfma_f32_32x32x16_bf16 v[96:111], v[40:43], v[52:55], v[96:111]
    v_mfma_f32_32x32x16_bf16 v[112:127], v[40:43], v[56:59], v[112:127]
    v_mfma_f32_32x32x16_bf16 v[112:127], v[44:47], v[52:55], v[112:127]
    v_mfma_f32_32x32x16_bf16 v[112:127], v[40:43], v[60:63], v[112:127]
    ds_read_b64 v[40:41], v1 offset:35872
    ds_read_b64 v[42:43], v1 offset:35880
    ds_read_b128 v[48:51], v2 offset:34160
    ds_read_b128 v[52:55], v2 offset:41840
    ds_read_b64 v[44:45], v1 offset:33824
    ds_read_b64 v[46:47], v1 offset:33832
    ds_read_b128 v[56:59], v2 offset:36720
    ds_read_b128 v[60:63], v2 offset:44400
    s_waitcnt lgkmcnt(8)
    v_mfma_f32_32x32x16_bf16 v[96:111], v[16:19], v[24:27], v[96:111]
    v_mfma_f32_32x32x16_bf16 v[112:127], v[20:23], v[24:27], v[112:127]
    v_mfma_f32_32x32x16_bf16 v[96:111], v[16:19], v[28:31], v[96:111]
    v_mfma_f32_32x32x16_bf16 v[112:127], v[16:19], v[32:35], v[112:127]
    v_mfma_f32_32x32x16_bf16 v[112:127], v[20:23], v[28:31], v[112:127]
    v_mfma_f32_32x32x16_bf16 v[112:127], v[16:19], v[36:39], v[112:127]
    ds_read_b64 v[16:17], v1 offset:35584
    ds_read_b64 v[18:19], v1 offset:35592
    ds_read_b128 v[24:27], v2 offset:33808
    ds_read_b128 v[28:31], v2 offset:41488
    ds_read_b64 v[20:21], v1 offset:33536
    ds_read_b64 v[22:23], v1 offset:33544
    ds_read_b128 v[32:35], v2 offset:36368
    ds_read_b128 v[36:39], v2 offset:44048
    s_waitcnt lgkmcnt(8)
    v_mfma_f32_32x32x16_bf16 v[96:111], v[40:43], v[48:51], v[96:111]
    v_mfma_f32_32x32x16_bf16 v[112:127], v[44:47], v[48:51], v[112:127]
    v_mfma_f32_32x32x16_bf16 v[96:111], v[40:43], v[52:55], v[96:111]
    v_mfma_f32_32x32x16_bf16 v[112:127], v[40:43], v[56:59], v[112:127]
    v_mfma_f32_32x32x16_bf16 v[112:127], v[44:47], v[52:55], v[112:127]
    v_mfma_f32_32x32x16_bf16 v[112:127], v[40:43], v[60:63], v[112:127]
    ds_read_b64 v[40:41], v1 offset:35616
    ds_read_b64 v[42:43], v1 offset:35624
    ds_read_b128 v[48:51], v2 offset:33840
    ds_read_b128 v[52:55], v2 offset:41520
    ds_read_b64 v[44:45], v1 offset:33568
    ds_read_b64 v[46:47], v1 offset:33576
    ds_read_b128 v[56:59], v2 offset:36400
    ds_read_b128 v[60:63], v2 offset:44080
    s_waitcnt lgkmcnt(8)
    v_mfma_f32_32x32x16_bf16 v[96:111], v[16:19], v[24:27], v[96:111]
    v_mfma_f32_32x32x16_bf16 v[112:127], v[20:23], v[24:27], v[112:127]
    v_mfma_f32_32x32x16_bf16 v[96:111], v[16:19], v[28:31], v[96:111]
    v_mfma_f32_32x32x16_bf16 v[112:127], v[16:19], v[32:35], v[112:127]
    v_mfma_f32_32x32x16_bf16 v[112:127], v[20:23], v[28:31], v[112:127]
    v_mfma_f32_32x32x16_bf16 v[112:127], v[16:19], v[36:39], v[112:127]
    ds_read_b64 v[16:17], v1 offset:35328
    ds_read_b64 v[18:19], v1 offset:35336
    ds_read_b128 v[24:27], v2 offset:33488
    ds_read_b128 v[28:31], v2 offset:41168
    ds_read_b64 v[20:21], v1 offset:33280
    ds_read_b64 v[22:23], v1 offset:33288
    ds_read_b128 v[32:35], v2 offset:36048
    ds_read_b128 v[36:39], v2 offset:43728
    s_waitcnt lgkmcnt(8)
    v_mfma_f32_32x32x16_bf16 v[96:111], v[40:43], v[48:51], v[96:111]
    v_mfma_f32_32x32x16_bf16 v[112:127], v[44:47], v[48:51], v[112:127]
    v_mfma_f32_32x32x16_bf16 v[96:111], v[40:43], v[52:55], v[96:111]
    v_mfma_f32_32x32x16_bf16 v[112:127], v[40:43], v[56:59], v[112:127]
    v_mfma_f32_32x32x16_bf16 v[112:127], v[44:47], v[52:55], v[112:127]
    v_mfma_f32_32x32x16_bf16 v[112:127], v[40:43], v[60:63], v[112:127]
    ds_read_b64 v[40:41], v1 offset:35360
    ds_read_b64 v[42:43], v1 offset:35368
    ds_read_b128 v[48:51], v2 offset:33520
    ds_read_b128 v[52:55], v2 offset:41200
    ds_read_b64 v[44:45], v1 offset:33312
    ds_read_b64 v[46:47], v1 offset:33320
    ds_read_b128 v[56:59], v2 offset:36080
    ds_read_b128 v[60:63], v2 offset:43760
    s_waitcnt lgkmcnt(8)
    v_mfma_f32_32x32x16_bf16 v[96:111], v[16:19], v[24:27], v[96:111]
    v_mfma_f32_32x32x16_bf16 v[112:127], v[20:23], v[24:27], v[112:127]
    v_mfma_f32_32x32x16_bf16 v[96:111], v[16:19], v[28:31], v[96:111]
    v_mfma_f32_32x32x16_bf16 v[112:127], v[16:19], v[32:35], v[112:127]
    v_mfma_f32_32x32x16_bf16 v[112:127], v[20:23], v[28:31], v[112:127]
    v_mfma_f32_32x32x16_bf16 v[112:127], v[16:19], v[36:39], v[112:127]
    ds_read_b64 v[16:17], v1 offset:35072
    ds_read_b64 v[18:19], v1 offset:35080
    ds_read_b128 v[24:27], v2 offset:33168
    ds_read_b128 v[28:31], v2 offset:40848
    ds_read_b64 v[20:21], v1 offset:33024
    ds_read_b64 v[22:23], v1 offset:33032
    ds_read_b128 v[32:35], v2 offset:35728
    ds_read_b128 v[36:39], v2 offset:43408
    s_waitcnt lgkmcnt(8)
    v_mfma_f32_32x32x16_bf16 v[96:111], v[40:43], v[48:51], v[96:111]
    v_mfma_f32_32x32x16_bf16 v[112:127], v[44:47], v[48:51], v[112:127]
    v_mfma_f32_32x32x16_bf16 v[96:111], v[40:43], v[52:55], v[96:111]
    v_mfma_f32_32x32x16_bf16 v[112:127], v[40:43], v[56:59], v[112:127]
    v_mfma_f32_32x32x16_bf16 v[112:127], v[44:47], v[52:55], v[112:127]
    v_mfma_f32_32x32x16_bf16 v[112:127], v[40:43], v[60:63], v[112:127]
    ds_read_b64 v[40:41], v1 offset:35104
    ds_read_b64 v[42:43], v1 offset:35112
    ds_read_b128 v[48:51], v2 offset:33200
    ds_read_b128 v[52:55], v2 offset:40880
    ds_read_b64 v[44:45], v1 offset:33056
    ds_read_b64 v[46:47], v1 offset:33064
    ds_read_b128 v[56:59], v2 offset:35760
    ds_read_b128 v[60:63], v2 offset:43440
    s_waitcnt lgkmcnt(8)
    v_mfma_f32_32x32x16_bf16 v[96:111], v[16:19], v[24:27], v[96:111]
    v_mfma_f32_32x32x16_bf16 v[112:127], v[20:23], v[24:27], v[112:127]
    v_mfma_f32_32x32x16_bf16 v[96:111], v[16:19], v[28:31], v[96:111]
    v_mfma_f32_32x32x16_bf16 v[112:127], v[16:19], v[32:35], v[112:127]
    v_mfma_f32_32x32x16_bf16 v[112:127], v[20:23], v[28:31], v[112:127]
    v_mfma_f32_32x32x16_bf16 v[112:127], v[16:19], v[36:39], v[112:127]
    ds_read_b64 v[16:17], v1 offset:34816
    ds_read_b64 v[18:19], v1 offset:34824
    ds_read_b128 v[24:27], v2 offset:32848
    ds_read_b128 v[28:31], v2 offset:40528
    ds_read_b64 v[20:21], v1 offset:32768
    ds_read_b64 v[22:23], v1 offset:32776
    ds_read_b128 v[32:35], v2 offset:35408
    ds_read_b128 v[36:39], v2 offset:43088
    s_waitcnt lgkmcnt(8)
    v_mfma_f32_32x32x16_bf16 v[96:111], v[40:43], v[48:51], v[96:111]
    v_mfma_f32_32x32x16_bf16 v[112:127], v[44:47], v[48:51], v[112:127]
    v_mfma_f32_32x32x16_bf16 v[96:111], v[40:43], v[52:55], v[96:111]
    v_mfma_f32_32x32x16_bf16 v[112:127], v[40:43], v[56:59], v[112:127]
    v_mfma_f32_32x32x16_bf16 v[112:127], v[44:47], v[52:55], v[112:127]
    v_mfma_f32_32x32x16_bf16 v[112:127], v[40:43], v[60:63], v[112:127]
    ds_read_b64 v[40:41], v1 offset:34848
    ds_read_b64 v[42:43], v1 offset:34856
    ds_read_b128 v[48:51], v2 offset:32880
    ds_read_b128 v[52:55], v2 offset:40560
    ds_read_b64 v[44:45], v1 offset:32800
    ds_read_b64 v[46:47], v1 offset:32808
    ds_read_b128 v[56:59], v2 offset:35440
    ds_read_b128 v[60:63], v2 offset:43120
    s_waitcnt lgkmcnt(8)
    v_mfma_f32_32x32x16_bf16 v[96:111], v[16:19], v[24:27], v[96:111]
    v_mfma_f32_32x32x16_bf16 v[112:127], v[20:23], v[24:27], v[112:127]
    v_mfma_f32_32x32x16_bf16 v[96:111], v[16:19], v[28:31], v[96:111]
    v_mfma_f32_32x32x16_bf16 v[112:127], v[16:19], v[32:35], v[112:127]
    v_mfma_f32_32x32x16_bf16 v[112:127], v[20:23], v[28:31], v[112:127]
    v_mfma_f32_32x32x16_bf16 v[112:127], v[16:19], v[36:39], v[112:127]
    s_waitcnt lgkmcnt(0)
    v_mfma_f32_32x32x16_bf16 v[96:111], v[40:43], v[48:51], v[96:111]
    v_mfma_f32_32x32x16_bf16 v[112:127], v[44:47], v[48:51], v[112:127]
    v_mfma_f32_32x32x16_bf16 v[96:111], v[40:43], v[52:55], v[96:111]
    v_mfma_f32_32x32x16_bf16 v[112:127], v[40:43], v[56:59], v[112:127]
    v_mfma_f32_32x32x16_bf16 v[112:127], v[44:47], v[52:55], v[112:127]
    v_mfma_f32_32x32x16_bf16 v[112:127], v[40:43], v[60:63], v[112:127]
    s_add_u32 s24, s16, 0x1400000
    s_addc_u32 s25, s17, 0
    s_and_b32 s25, s25, 0xffff
    s_mov_b32 s26, 0x18000
    s_mov_b32 s27, 0x20000
    s_nop 7
    s_barrier
    s_lshl_b32 s14, s3, 13
    v_lshlrev_b32 v1, 4, v0
    v_add_u32 v2, s14, v1

    ds_write_b128 v2, v[64:67] offset:0
    ds_write_b128 v2, v[68:71] offset:1024
    ds_write_b128 v2, v[72:75] offset:2048
    ds_write_b128 v2, v[76:79] offset:3072
    ds_write_b128 v2, v[80:83] offset:4096
    ds_write_b128 v2, v[84:87] offset:5120
    ds_write_b128 v2, v[88:91] offset:6144
    ds_write_b128 v2, v[92:95] offset:7168
    ds_write_b128 v2, v[96:99] offset:32768
    ds_write_b128 v2, v[100:103] offset:33792
    ds_write_b128 v2, v[104:107] offset:34816
    ds_write_b128 v2, v[108:111] offset:35840
    ds_write_b128 v2, v[112:115] offset:36864
    ds_write_b128 v2, v[116:119] offset:37888
    ds_write_b128 v2, v[120:123] offset:38912
    ds_write_b128 v2, v[124:127] offset:39936
    s_lshl_b32 s14, s3, 11
    v_lshlrev_b32 v1, 4, v5
    v_lshl_add_u32 v1, v6, 10, v1
    v_add_u32 v1, s14, v1
    s_lshr_b32 s45, s2, 5
    s_lshr_b32 s14, s3, 1
    s_lshl_b32 s14, s14, 7
    s_add_u32 s45, s45, s14
    s_add_u32 s45, s45, 128
    s_lshl_b32 s45, s45, 8
    s_and_b32 s14, s2, 31
    s_lshl_b32 s14, s14, 1
    s_and_b32 s15, s3, 1
    s_add_u32 s14, s14, s15
    s_lshl_b32 s14, s14, 2
    s_add_u32 s45, s45, s14
    s_waitcnt lgkmcnt(0)
    s_barrier

    ds_read_b128 v[64:67], v1 offset:0
    ds_read_b128 v[68:71], v1 offset:512
    ds_read_b128 v[72:75], v1 offset:8192
    ds_read_b128 v[76:79], v1 offset:8704
    ds_read_b128 v[80:83], v1 offset:16384
    ds_read_b128 v[84:87], v1 offset:16896
    ds_read_b128 v[88:91], v1 offset:24576
    ds_read_b128 v[92:95], v1 offset:25088
    ds_read_b128 v[96:99], v1 offset:32768
    ds_read_b128 v[100:103], v1 offset:33280
    ds_read_b128 v[104:107], v1 offset:40960
    ds_read_b128 v[108:111], v1 offset:41472
    ds_read_b128 v[112:115], v1 offset:49152
    ds_read_b128 v[116:119], v1 offset:49664
    ds_read_b128 v[120:123], v1 offset:57344
    ds_read_b128 v[124:127], v1 offset:57856
    s_waitcnt lgkmcnt(0) vmcnt(0)
    v_lshlrev_b32 v190, 16, v190
    v_add_f32 v64, v64, v72
    v_add_f32 v80, v80, v88
    v_add_f32 v64, v64, v80
    v_add_f32 v65, v65, v73
    v_add_f32 v81, v81, v89
    v_add_f32 v65, v65, v81
    v_add_f32 v66, v66, v74
    v_add_f32 v82, v82, v90
    v_add_f32 v66, v66, v82
    v_add_f32 v67, v67, v75
    v_add_f32 v83, v83, v91
    v_add_f32 v67, v67, v83
    v_cvt_pk_bf16_f32 v48, v64, v65
    v_lshlrev_b32 v49, 16, v48
    v_and_b32 v50, 0xffff0000, v48
    v_lshlrev_b32 v51, 16, v192
    v_and_b32 v52, 0xffff0000, v192
    v_mul_f32 v51, v51, v190
    v_mul_f32 v52, v52, v190
    v_cvt_pk_bf16_f32 v48, v51, v52
    v_lshlrev_b32 v51, 16, v48
    v_and_b32 v52, 0xffff0000, v48
    v_add_f32 v49, v49, v51
    v_add_f32 v50, v50, v52
    v_cvt_pk_bf16_f32 v56, v49, v50

    v_cvt_pk_bf16_f32 v48, v66, v67
    v_lshlrev_b32 v49, 16, v48
    v_and_b32 v50, 0xffff0000, v48
    v_lshlrev_b32 v51, 16, v193
    v_and_b32 v52, 0xffff0000, v193
    v_mul_f32 v51, v51, v190
    v_mul_f32 v52, v52, v190
    v_cvt_pk_bf16_f32 v48, v51, v52
    v_lshlrev_b32 v51, 16, v48
    v_and_b32 v52, 0xffff0000, v48
    v_add_f32 v49, v49, v51
    v_add_f32 v50, v50, v52
    v_cvt_pk_bf16_f32 v57, v49, v50

    v_add_f32 v68, v68, v76
    v_add_f32 v84, v84, v92
    v_add_f32 v68, v68, v84
    v_add_f32 v69, v69, v77
    v_add_f32 v85, v85, v93
    v_add_f32 v69, v69, v85
    v_add_f32 v70, v70, v78
    v_add_f32 v86, v86, v94
    v_add_f32 v70, v70, v86
    v_add_f32 v71, v71, v79
    v_add_f32 v87, v87, v95
    v_add_f32 v71, v71, v87
    v_cvt_pk_bf16_f32 v48, v68, v69
    v_lshlrev_b32 v49, 16, v48
    v_and_b32 v50, 0xffff0000, v48
    v_lshlrev_b32 v51, 16, v194
    v_and_b32 v52, 0xffff0000, v194
    v_mul_f32 v51, v51, v190
    v_mul_f32 v52, v52, v190
    v_cvt_pk_bf16_f32 v48, v51, v52
    v_lshlrev_b32 v51, 16, v48
    v_and_b32 v52, 0xffff0000, v48
    v_add_f32 v49, v49, v51
    v_add_f32 v50, v50, v52
    v_cvt_pk_bf16_f32 v58, v49, v50

    v_cvt_pk_bf16_f32 v48, v70, v71
    v_lshlrev_b32 v49, 16, v48
    v_and_b32 v50, 0xffff0000, v48
    v_lshlrev_b32 v51, 16, v195
    v_and_b32 v52, 0xffff0000, v195
    v_mul_f32 v51, v51, v190
    v_mul_f32 v52, v52, v190
    v_cvt_pk_bf16_f32 v48, v51, v52
    v_lshlrev_b32 v51, 16, v48
    v_and_b32 v52, 0xffff0000, v48
    v_add_f32 v49, v49, v51
    v_add_f32 v50, v50, v52
    v_cvt_pk_bf16_f32 v59, v49, v50

    buffer_store_dwordx4 v[56:59], v13, s[32:35], s43 offen sc1
    v_lshlrev_b32 v206, 16, v206
    v_add_f32 v96, v96, v104
    v_add_f32 v112, v112, v120
    v_add_f32 v96, v96, v112
    v_add_f32 v97, v97, v105
    v_add_f32 v113, v113, v121
    v_add_f32 v97, v97, v113
    v_add_f32 v98, v98, v106
    v_add_f32 v114, v114, v122
    v_add_f32 v98, v98, v114
    v_add_f32 v99, v99, v107
    v_add_f32 v115, v115, v123
    v_add_f32 v99, v99, v115
    v_cvt_pk_bf16_f32 v48, v96, v97
    v_lshlrev_b32 v49, 16, v48
    v_and_b32 v50, 0xffff0000, v48
    v_lshlrev_b32 v51, 16, v208
    v_and_b32 v52, 0xffff0000, v208
    v_mul_f32 v51, v51, v206
    v_mul_f32 v52, v52, v206
    v_cvt_pk_bf16_f32 v48, v51, v52
    v_lshlrev_b32 v51, 16, v48
    v_and_b32 v52, 0xffff0000, v48
    v_add_f32 v49, v49, v51
    v_add_f32 v50, v50, v52
    v_cvt_pk_bf16_f32 v60, v49, v50

    v_cvt_pk_bf16_f32 v48, v98, v99
    v_lshlrev_b32 v49, 16, v48
    v_and_b32 v50, 0xffff0000, v48
    v_lshlrev_b32 v51, 16, v209
    v_and_b32 v52, 0xffff0000, v209
    v_mul_f32 v51, v51, v206
    v_mul_f32 v52, v52, v206
    v_cvt_pk_bf16_f32 v48, v51, v52
    v_lshlrev_b32 v51, 16, v48
    v_and_b32 v52, 0xffff0000, v48
    v_add_f32 v49, v49, v51
    v_add_f32 v50, v50, v52
    v_cvt_pk_bf16_f32 v61, v49, v50

    v_add_f32 v100, v100, v108
    v_add_f32 v116, v116, v124
    v_add_f32 v100, v100, v116
    v_add_f32 v101, v101, v109
    v_add_f32 v117, v117, v125
    v_add_f32 v101, v101, v117
    v_add_f32 v102, v102, v110
    v_add_f32 v118, v118, v126
    v_add_f32 v102, v102, v118
    v_add_f32 v103, v103, v111
    v_add_f32 v119, v119, v127
    v_add_f32 v103, v103, v119
    v_cvt_pk_bf16_f32 v48, v100, v101
    v_lshlrev_b32 v49, 16, v48
    v_and_b32 v50, 0xffff0000, v48
    v_lshlrev_b32 v51, 16, v210
    v_and_b32 v52, 0xffff0000, v210
    v_mul_f32 v51, v51, v206
    v_mul_f32 v52, v52, v206
    v_cvt_pk_bf16_f32 v48, v51, v52
    v_lshlrev_b32 v51, 16, v48
    v_and_b32 v52, 0xffff0000, v48
    v_add_f32 v49, v49, v51
    v_add_f32 v50, v50, v52
    v_cvt_pk_bf16_f32 v62, v49, v50

    v_cvt_pk_bf16_f32 v48, v102, v103
    v_lshlrev_b32 v49, 16, v48
    v_and_b32 v50, 0xffff0000, v48
    v_lshlrev_b32 v51, 16, v211
    v_and_b32 v52, 0xffff0000, v211
    v_mul_f32 v51, v51, v206
    v_mul_f32 v52, v52, v206
    v_cvt_pk_bf16_f32 v48, v51, v52
    v_lshlrev_b32 v51, 16, v48
    v_and_b32 v52, 0xffff0000, v48
    v_add_f32 v49, v49, v51
    v_add_f32 v50, v50, v52
    v_cvt_pk_bf16_f32 v63, v49, v50

    buffer_store_dwordx4 v[60:63], v13, s[32:35], s44 offen sc1

    s_endpgm
L1_exit:
    s_endpgm

.section .rodata,"a"
.p2align 6
.amdhsa_kernel prep_kernel
  .amdhsa_next_free_vgpr 72
  .amdhsa_next_free_sgpr 100
  .amdhsa_accum_offset 72
  .amdhsa_group_segment_fixed_size 0
  .amdhsa_kernarg_size 112
  .amdhsa_user_sgpr_count 2
  .amdhsa_user_sgpr_kernarg_segment_ptr 1
  .amdhsa_system_sgpr_workgroup_id_x 1
.end_amdhsa_kernel
.p2align 6
.amdhsa_kernel main_kernel
  .amdhsa_next_free_vgpr 256
  .amdhsa_next_free_sgpr 100
  .amdhsa_accum_offset 256
  .amdhsa_group_segment_fixed_size 0
  .amdhsa_kernarg_size 112
  .amdhsa_user_sgpr_count 2
  .amdhsa_user_sgpr_kernarg_segment_ptr 1
  .amdhsa_system_sgpr_workgroup_id_x 1
.end_amdhsa_kernel
```
